```python
import torch

def _softmax(x, axis=-1):
    return torch.softmax(x, dim=axis)
def _gelu(x):
    return torch.nn.functional.gelu(x, approximate="tanh")
def _silu(x):
    return torch.nn.functional.silu(x)
def _sigmoid(x):
    return torch.sigmoid(x)
def _layernorm(x, axis=-1, eps=1e-5):
    m = x.mean(dim=axis, keepdim=True)
    v = x.var(dim=axis, keepdim=True, unbiased=False)
    return (x - m) / torch.sqrt(v + eps)
def _scatter_add(tgt, idx, src, axis=0):
    return tgt.clone().index_add_(axis, idx, src)
def _segment_sum(src, seg, n):
    out = torch.zeros((n,) + src.shape[1:], dtype=src.dtype)
    return out.index_add_(0, seg, src)
def _pad(x, pw):
    flat = tuple(v for pair in reversed(pw) for v in pair)
    return torch.nn.functional.pad(x, flat)

kernel_name = 'interleave_layers__mha_block_cached__glu_gated_reglu__decode'

def setup_inputs():

    _w = (lambda a: (lambda t: t.to(torch.bfloat16) if t.is_floating_point() else t)(torch.as_tensor(a)))
    def _A_setup():
        B, Sq, D = 2, 1, 448
        H, Sk, Dh = 16, 4096, 256
        return {
            "x": _w((lambda *s: torch.randn(*s, dtype=torch.bfloat16) * 0.05)(B, Sq, D)),
            "k_cache": _w((lambda *s: torch.randn(*s, dtype=torch.bfloat16) * 1.6)(B, H, Sk, Dh)),
            "v_cache": _w((lambda *s: torch.randn(*s, dtype=torch.bfloat16) * 0.8)(B, H, Sk, Dh)),
            "wq": _w((lambda *s: torch.randn(*s, dtype=torch.bfloat16) * 1.6)(D, H * Dh) * (D ** -0.5)),
            "wo": _w((lambda *s: torch.randn(*s, dtype=torch.bfloat16) * 0.8)(H * Dh, D) * ((H * Dh) ** -0.5)),
        }
    _A_in = _A_setup()

    def _B_setup():
        B, S, D, F = 2, 1, 448, 1792
        return {
            "x": _w((lambda *s: torch.randn(*s, dtype=torch.bfloat16) * 0.05)(B, S, D)),
            "W_gate": _w((lambda *s: torch.randn(*s, dtype=torch.bfloat16) * 0.4)(D, F) * (2.0 / D) ** 0.5),
            "W_up": _w((lambda *s: torch.randn(*s, dtype=torch.bfloat16) * 0.4)(D, F) * (2.0 / D) ** 0.5),
            "W_down": _w((lambda *s: torch.randn(*s, dtype=torch.bfloat16) * 0.4)(F, D) * (1.0 / F) ** 0.5),
        }
    _B_in = _B_setup()

    return {
        "A_x": _A_in["x"],
        "A_k_cache": _A_in["k_cache"],
        "A_v_cache": _A_in["v_cache"],
        "A_wq": _A_in["wq"],
        "A_wo": _A_in["wo"],
        "B_x": _B_in["x"],
        "B_W_gate": _B_in["W_gate"],
        "B_W_up": _B_in["W_up"],
        "B_W_down": _B_in["W_down"],
    }

def reference(A_x, A_k_cache, A_v_cache, A_wq, A_wo, B_x, B_W_gate, B_W_up, B_W_down):
    def _A_ref(x, k_cache, v_cache, wq, wo):
        B, Sq, D = x.shape
        H, Dh = 16, 256
        q = (lambda x, *d: x.permute(*d))((x @ wq).reshape(B, Sq, H, Dh), 0, 2, 1, 3)
        scores = torch.einsum("bhqd,bhkd->bhqk", q, k_cache) * (Dh ** -0.5)
        p = _softmax(scores, axis=-1)
        o = torch.einsum("bhqk,bhkd->bhqd", p, v_cache)
        return (lambda x, *d: x.permute(*d))(o, 0, 2, 1, 3).reshape(B, Sq, H * Dh) @ wo

    def _B_ref(x, W_gate, W_up, W_down):
        gate = torch.einsum("bsd,df->bsf", x, W_gate)
        up = torch.einsum("bsd,df->bsf", x, W_up)
        gate = gate * (lambda x, dt: x.to(dt))(gate > 0, gate.dtype)
        h = gate * up
        return torch.einsum("bsf,fd->bsd", h, W_down)

    x = A_x
    x = x + _A_ref(_layernorm(x, axis=-1), A_k_cache, A_v_cache, A_wq, A_wo)
    x = x + _B_ref(_layernorm(x, axis=-1), B_W_gate, B_W_up, B_W_down)
    x = x + _A_ref(_layernorm(x, axis=-1), A_k_cache, A_v_cache, A_wq, A_wo)
    x = x + _B_ref(_layernorm(x, axis=-1), B_W_gate, B_W_up, B_W_down)
    return x
```

```asm
; @launch grid=(256,1,1) block=(256,1,1) lds=163152
.amdgcn_target "amdgcn-amd-amdhsa--gfx950"
.text
.globl interleave_layers__mha_block_cached__glu_gated_reglu__decode_kernel
.p2align 8
.type interleave_layers__mha_block_cached__glu_gated_reglu__decode_kernel,@function
interleave_layers__mha_block_cached__glu_gated_reglu__decode_kernel:
  s_cmp_ge_u32 s2, 256
  s_cbranch_scc1 L_end
  s_load_dwordx16 s[64:79], s[0:1], 0
  s_load_dwordx8 s[80:87], s[0:1], 64
  s_getpc_b64 s[98:99]
  v_lshlrev_b32 v12, 4, v0
  global_load_dwordx4 v[64:67], v12, s[98:99]
  v_add_u32 v12, 4096, v12
  global_load_dwordx4 v[68:71], v12, s[98:99]
  v_add_u32 v12, 4096, v12
  global_load_dwordx4 v[72:75], v12, s[98:99]
  v_add_u32 v12, 4096, v12
  global_load_dwordx4 v[76:79], v12, s[98:99]
  v_add_u32 v12, 4096, v12
  global_load_dwordx4 v[64:67], v12, s[98:99]
  v_lshrrev_b32 v1, 6, v0
  v_and_b32 v0, 63, v0
  v_readfirstlane_b32 s3, v1
  s_and_b32 s4, s2, 7
  s_lshr_b32 s5, s2, 3
  s_lshl_b32 s6, s4, 1
  s_lshr_b32 s98, s5, 4
  s_add_u32 s6, s6, s98
  s_and_b32 s7, s5, 15
  s_lshr_b32 s55, s7, 3
  s_lshl_b32 s96, s55, 25
  s_lshl_b32 s98, s6, 21
  s_add_u32 s96, s96, s98
  s_and_b32 s98, s7, 7
  s_lshl_b32 s98, s98, 18
  s_add_u32 s96, s96, s98
  s_lshl_b32 s98, s3, 16
  s_add_u32 s96, s96, s98
  s_lshl_b32 s97, s3, 1
  s_add_u32 s97, s97, s5
  s_add_u32 s97, s97, s4
  s_add_u32 s98, s97, 0
  s_and_b32 s98, s98, 7
  s_lshl_b32 s98, s98, 13
  s_add_u32 s56, s96, s98
  s_add_u32 s98, s97, 1
  s_and_b32 s98, s98, 7
  s_lshl_b32 s98, s98, 13
  s_add_u32 s57, s96, s98
  v_lshrrev_b32 v250, 5, v0
  v_bfe_u32 v251, v0, 2, 3
  v_and_b32 v252, 3, v0
  v_lshlrev_b32 v252, 4, v252
  v_lshl_add_u32 v252, v250, 9, v252
  v_xor_b32 v248, v251, v250
  v_lshl_add_u32 v248, v248, 6, v252
  v_add_u32 v250, 2, v250
  v_xor_b32 v249, v251, v250
  v_lshl_add_u32 v249, v249, 6, v252
  s_waitcnt lgkmcnt(0)
  s_mul_i32 s0, s3, 26624
  s_mov_b32 s12, s66
  s_mov_b32 s13, s67
  s_mov_b32 s14, 67108864
  s_mov_b32 s15, 0x20000
  s_mov_b32 s20, s70
  s_mov_b32 s21, s71
  s_mov_b32 s22, 3670016
  s_mov_b32 s23, 0x20000
  s_lshl_b32 s99, s6, 9
  s_lshl_b32 s98, s7, 5
  s_add_u32 s99, s99, s98
  v_lshrrev_b32 v19, 1, v0
  v_lshlrev_b32 v19, 13, v19
  v_and_b32 v23, 1, v0
  v_lshl_add_u32 v19, v23, 4, v19
  v_add_u32 v19, s99, v19
  s_add_u32 m0, s0, 0
  s_nop 0
  buffer_load_dwordx4 v248, s[12:15], s56 offen offset:0 nt lds
  buffer_load_dwordx4 v249, s[12:15], s56 offen offset:1024 nt lds
  buffer_load_dwordx4 v248, s[12:15], s56 offen offset:2048 nt lds
  buffer_load_dwordx4 v249, s[12:15], s56 offen offset:3072 nt lds
  s_add_u32 s99, s3, 0
  s_lshl_b32 s98, s99, 18
  s_lshl_b32 s99, s99, 10
  s_add_u32 m0, s99, 122880
  s_nop 0
  buffer_load_dwordx4 v19, s[20:23], s98 offen  lds
  s_add_u32 m0, s0, 4096
  s_add_u32 s98, s56, 4096
  buffer_load_dwordx4 v248, s[12:15], s98 offen offset:0 nt lds
  buffer_load_dwordx4 v249, s[12:15], s98 offen offset:1024 nt lds
  buffer_load_dwordx4 v248, s[12:15], s98 offen offset:2048 nt lds
  buffer_load_dwordx4 v249, s[12:15], s98 offen offset:3072 nt lds
  s_add_u32 s99, s3, 4
  s_lshl_b32 s98, s99, 18
  s_lshl_b32 s99, s99, 10
  s_add_u32 m0, s99, 122880
  s_nop 0
  buffer_load_dwordx4 v19, s[20:23], s98 offen  lds
  s_add_u32 m0, s0, 8192
  s_nop 0
  buffer_load_dwordx4 v248, s[12:15], s57 offen offset:0 nt lds
  buffer_load_dwordx4 v249, s[12:15], s57 offen offset:1024 nt lds
  buffer_load_dwordx4 v248, s[12:15], s57 offen offset:2048 nt lds
  buffer_load_dwordx4 v249, s[12:15], s57 offen offset:3072 nt lds
  s_add_u32 s99, s3, 8
  s_lshl_b32 s98, s99, 18
  s_lshl_b32 s99, s99, 10
  s_add_u32 m0, s99, 122880
  s_nop 0
  buffer_load_dwordx4 v19, s[20:23], s98 offen  lds
  s_add_u32 m0, s0, 12288
  s_add_u32 s98, s57, 4096
  buffer_load_dwordx4 v248, s[12:15], s98 offen offset:0 nt lds
  buffer_load_dwordx4 v249, s[12:15], s98 offen offset:1024 nt lds
  buffer_load_dwordx4 v248, s[12:15], s98 offen offset:2048 nt lds
  buffer_load_dwordx4 v249, s[12:15], s98 offen offset:3072 nt lds
  s_bitcmp1_b32 s3, 0
  s_cbranch_scc1 L_qdm_1
  s_lshr_b32 s99, s3, 1
  s_add_u32 s99, s99, 12
  s_lshl_b32 s98, s99, 18
  s_lshl_b32 s99, s99, 10
  s_add_u32 m0, s99, 122880
  s_nop 0
  buffer_load_dwordx4 v19, s[20:23], s98 offen  lds
  L_qdn_2:
  s_mov_b32 s40, s64
  s_mov_b32 s41, s65
  s_mov_b32 s42, 1792
  s_mov_b32 s43, 0x20000
  s_mov_b32 s8, s86
  s_mov_b32 s9, s87
  s_mov_b32 s10, 802816
  s_mov_b32 s11, 0x20000
  s_mov_b32 s92, -1
  s_mov_b32 s93, 0x00FFFFFF
  s_cmp_eq_u32 s3, 1
  s_cbranch_scc0 L_w1early_3
  v_and_b32 v12, 1, v0
  v_mul_u32_u24 v12, 896, v12
  v_lshrrev_b32 v13, 1, v0
  v_lshl_add_u32 v12, v13, 5, v12
  v_mov_b32 v96, 0
  v_mov_b32 v97, 0
  v_mov_b32 v98, 0
  v_mov_b32 v99, 0
  v_mov_b32 v100, 0
  v_mov_b32 v101, 0
  v_mov_b32 v102, 0
  v_mov_b32 v103, 0
  s_mov_b64 exec, s[92:93]
  buffer_load_dwordx4 v[96:99], v12, s[40:43], 0 offen
  buffer_load_dwordx4 v[100:103], v12, s[40:43], 0 offen offset:16
  s_mov_b64 exec, -1
  L_w1early_3:
  s_add_u32 s98, s97, 2
  s_and_b32 s98, s98, 7
  s_lshl_b32 s98, s98, 13
  s_add_u32 s58, s96, s98
  s_add_u32 s98, s97, 3
  s_and_b32 s98, s98, 7
  s_lshl_b32 s98, s98, 13
  s_add_u32 s59, s96, s98
  s_add_u32 s98, s97, 4
  s_and_b32 s98, s98, 7
  s_lshl_b32 s98, s98, 13
  s_add_u32 s60, s96, s98
  s_add_u32 s98, s97, 5
  s_and_b32 s98, s98, 7
  s_lshl_b32 s98, s98, 13
  s_add_u32 s61, s96, s98
  s_add_u32 s98, s97, 6
  s_and_b32 s98, s98, 7
  s_lshl_b32 s98, s98, 13
  s_add_u32 s62, s96, s98
  s_add_u32 s98, s97, 7
  s_and_b32 s98, s98, 7
  s_lshl_b32 s98, s98, 13
  s_add_u32 s63, s96, s98
  v_and_b32 v254, 15, v0
  v_lshrrev_b32 v255, 4, v0
  v_lshlrev_b32 v255, 4, v255
  v_lshl_add_u32 v255, v254, 9, v255
  v_add_u32 v255, s0, v255
  v_and_b32 v254, 3, v254
  v_xor_b32 v250, 0, v254
  v_lshl_add_u32 v250, v250, 6, v255
  v_xor_b32 v251, 1, v254
  v_lshl_add_u32 v251, v251, 6, v255
  v_xor_b32 v252, 2, v254
  v_lshl_add_u32 v252, v252, 6, v255
  v_xor_b32 v253, 3, v254
  v_lshl_add_u32 v253, v253, 6, v255
  s_mov_b32 s16, s68
  s_mov_b32 s17, s69
  s_mov_b32 s18, 67108864
  s_mov_b32 s19, 0x20000
  s_mov_b32 s24, s72
  s_mov_b32 s25, s73
  s_mov_b32 s26, 3670016
  s_mov_b32 s27, 0x20000
  s_mov_b32 s28, s76
  s_mov_b32 s29, s77
  s_mov_b32 s30, 1605632
  s_mov_b32 s31, 0x20000
  s_mov_b32 s32, s78
  s_mov_b32 s33, s79
  s_mov_b32 s34, 1605632
  s_mov_b32 s35, 0x20000
  s_mov_b32 s36, s80
  s_mov_b32 s37, s81
  s_mov_b32 s38, 1605632
  s_mov_b32 s39, 0x20000
  s_mov_b32 s44, s82
  s_mov_b32 s45, s83
  s_mov_b32 s46, 1792
  s_mov_b32 s47, 0x20000
  s_mov_b32 s48, s84
  s_mov_b32 s49, s85
  s_mov_b32 s96, 0x3F803F80
  s_mov_b32 s97, 0x3DB8AA3B
  v_and_b32 v1, 15, v0
  v_lshrrev_b32 v2, 4, v0
  s_mov_b32 s50, 0
  s_mov_b32 s51, 0
  s_mov_b32 s52, 0
  s_mov_b32 s53, 0x40000
  s_mov_b32 s88, 0x01010101
  s_mov_b32 s89, 0x01010101
  s_mov_b32 s90, 0x00030003
  s_mov_b32 s91, 0x00030003
  s_mov_b32 s94, 0xFF
  s_mov_b32 s95, 0xFF
  s_getreg_b32 s54, hwreg(HW_REG_XCC_ID, 0, 4)
  s_or_b32 s54, s54, 0x80
  v_and_b32 v20, 1, v2
  v_lshrrev_b32 v21, 1, v2
  v_lshl_add_u32 v20, v20, 1, v21
  v_lshlrev_b32 v20, 9, v20
  v_lshl_add_u32 v20, v1, 4, v20
  v_add_u32 v21, 4096, v20
  v_and_b32 v12, 1, v0
  v_mul_u32_u24 v12, 0xAAAA, v12
  v_add_u32 v8, 0x4444, v12
  v_and_b32 v12, 3, v0
  v_mul_u32_u24 v9, 0x1111, v12
  v_lshrrev_b32 v12, 3, v1
  v_lshrrev_b32 v13, 1, v2
  v_cmp_eq_u32 vcc, v12, v13
  v_mov_b32 v13, 0xFFFF
  s_nop 0
  v_cndmask_b32 v13, 0, v13, vcc
  v_bfe_u32 v12, v0, 2, 1
  v_cmp_eq_u32 vcc, 0, v12
  s_nop 1
  v_cndmask_b32 v4, 0, v13, vcc
  v_cmp_eq_u32 vcc, 1, v12
  s_nop 1
  v_cndmask_b32 v5, 0, v13, vcc
  s_lshl_b32 s98, s6, 10
  s_lshl_b32 s99, s55, 9
  s_add_u32 s98, s98, s99
  v_and_b32 v12, 1, v0
  v_lshlrev_b32 v12, 4, v12
  v_lshl_add_u32 v12, v2, 5, v12
  v_add_u32 v12, s98, v12
  v_bfe_u32 v13, v0, 1, 1
  v_mov_b32 v10, 2130706432
  v_cmp_eq_u32 vcc, 0, v13
  s_nop 1
  v_cndmask_b32 v10, v10, v12, vcc
  s_cmp_eq_u32 s3, 2
  s_cbranch_scc0 L_cx_5
  v_bfe_u32 v12, v0, 2, 1
  v_mul_u32_u24 v12, 896, v12
  v_and_b32 v23, 3, v0
  v_lshl_add_u32 v12, v23, 3, v12
  v_lshl_add_u32 v12, v2, 1, v12
  s_lshl_b32 s98, s5, 5
  v_add_u32 v12, s98, v12
  buffer_load_ushort v11, v12, s[40:43], 0 offen
  L_cx_5:
  s_waitcnt vmcnt(11)
  ds_read_b128 a[0:3], v250 offset:0
  ds_read_b128 a[4:7], v251 offset:0
  ds_read_b128 a[8:11], v252 offset:0
  ds_read_b128 a[12:15], v253 offset:0
  ds_read_b128 a[16:19], v250 offset:256
  ds_read_b128 a[20:23], v251 offset:256
  ds_read_b128 a[24:27], v252 offset:256
  ds_read_b128 a[28:31], v253 offset:256
  s_waitcnt lgkmcnt(0)
  s_add_u32 m0, s0, 16384
  s_nop 0
  buffer_load_dwordx4 v248, s[12:15], s58 offen offset:0 nt lds
  buffer_load_dwordx4 v249, s[12:15], s58 offen offset:1024 nt lds
  buffer_load_dwordx4 v248, s[12:15], s58 offen offset:2048 nt lds
  buffer_load_dwordx4 v249, s[12:15], s58 offen offset:3072 nt lds
  s_add_u32 m0, s0, 20480
  s_add_u32 s98, s58, 4096
  buffer_load_dwordx4 v248, s[12:15], s98 offen offset:0 nt lds
  buffer_load_dwordx4 v249, s[12:15], s98 offen offset:1024 nt lds
  buffer_load_dwordx4 v248, s[12:15], s98 offen offset:2048 nt lds
  buffer_load_dwordx4 v249, s[12:15], s98 offen offset:3072 nt lds
  s_waitcnt vmcnt(9)
  ds_read_b128 a[32:35], v250 offset:8192
  ds_read_b128 a[36:39], v251 offset:8192
  ds_read_b128 a[40:43], v252 offset:8192
  ds_read_b128 a[44:47], v253 offset:8192
  ds_read_b128 a[48:51], v250 offset:8448
  ds_read_b128 a[52:55], v251 offset:8448
  ds_read_b128 a[56:59], v252 offset:8448
  ds_read_b128 a[60:63], v253 offset:8448
  s_waitcnt lgkmcnt(0)
  s_add_u32 m0, s0, 0
  s_nop 0
  buffer_load_dwordx4 v248, s[12:15], s59 offen offset:0 nt lds
  buffer_load_dwordx4 v249, s[12:15], s59 offen offset:1024 nt lds
  buffer_load_dwordx4 v248, s[12:15], s59 offen offset:2048 nt lds
  buffer_load_dwordx4 v249, s[12:15], s59 offen offset:3072 nt lds
  s_add_u32 m0, s0, 4096
  s_add_u32 s98, s59, 4096
  buffer_load_dwordx4 v248, s[12:15], s98 offen offset:0 nt lds
  buffer_load_dwordx4 v249, s[12:15], s98 offen offset:1024 nt lds
  buffer_load_dwordx4 v248, s[12:15], s98 offen offset:2048 nt lds
  buffer_load_dwordx4 v249, s[12:15], s98 offen offset:3072 nt lds
  s_waitcnt vmcnt(8)
  ds_read_b128 a[64:67], v250 offset:16384
  ds_read_b128 a[68:71], v251 offset:16384
  ds_read_b128 a[72:75], v252 offset:16384
  ds_read_b128 a[76:79], v253 offset:16384
  ds_read_b128 a[80:83], v250 offset:16640
  ds_read_b128 a[84:87], v251 offset:16640
  ds_read_b128 a[88:91], v252 offset:16640
  ds_read_b128 a[92:95], v253 offset:16640
  s_cmp_eq_u32 s3, 0
  s_cbranch_scc0 L_arm_6
  v_lshlrev_b32 v12, 2, v0
  v_add_u32 v12, 162880, v12
  v_mov_b32 v13, -1
  ds_write_b32 v12, v13
  v_mov_b32 v12, 163136
  v_mov_b32 v13, 0
  ds_write_b32 v12, v13
  L_arm_6:
  s_waitcnt lgkmcnt(0)
  s_barrier
  L_top:
  s_cmp_eq_u32 s3, 1
  s_cbranch_scc0 L_ns7_7
  s_cmp_eq_u32 s51, 0
  s_cbranch_scc0 L_clr_9
  v_mov_b32 v24, -1
  v_mov_b32 v25, -1
  v_mov_b32 v26, -1
  v_mov_b32 v27, -1
  s_mul_i32 s98, s2, 3072
  s_add_u32 s98, s98, 0x4000
  v_lshlrev_b32 v12, 4, v0
  buffer_store_dwordx4 v[24:27], v12, s[8:11], s98 offen offset:0 sc1
  buffer_store_dwordx4 v[24:27], v12, s[8:11], s98 offen offset:1024 sc1
  buffer_store_dwordx4 v[24:27], v12, s[8:11], s98 offen offset:2048 sc1
  L_clr_9:
  s_cmp_eq_u32 s51, 0
  s_cbranch_scc0 L_perm_10
  v_mov_b32 v88, v97
  v_mov_b32 v89, v99
  v_mov_b32 v90, v101
  v_mov_b32 v97, v98
  v_mov_b32 v98, v100
  v_mov_b32 v99, v102
  v_mov_b32 v100, v88
  v_mov_b32 v101, v89
  v_mov_b32 v102, v90
  L_perm_10:
  v_and_b32 v12, 1, v0
  v_mul_u32_u24 v12, 896, v12
  v_lshrrev_b32 v13, 1, v0
  v_lshl_add_u32 v12, v13, 5, v12
  v_add_u32 v13, 160768, v12
  v_bfe_u32 v14, v0, 1, 1
  v_mul_u32_u24 v14, 896, v14
  v_lshl_add_u32 v14, v2, 5, v14
  v_and_b32 v23, 1, v0
  v_lshl_add_u32 v14, v23, 4, v14
  v_add_u32 v14, 160768, v14
  v_lshrrev_b32 v15, 2, v1
  v_lshl_add_u32 v15, v2, 3, v15
  v_lshlrev_b32 v15, 5, v15
  v_and_b32 v23, 3, v0
  v_lshl_add_u32 v15, v23, 3, v15
  v_add_u32 v15, 122880, v15
  ds_read_b64_tr_b16 v[24:25], v15 offset:0
  ds_read_b64_tr_b16 v[26:27], v15 offset:128
  ds_read_b64_tr_b16 v[28:29], v15 offset:1024
  ds_read_b64_tr_b16 v[30:31], v15 offset:1152
  ds_read_b64_tr_b16 v[32:33], v15 offset:2048
  ds_read_b64_tr_b16 v[34:35], v15 offset:2176
  ds_read_b64_tr_b16 v[36:37], v15 offset:3072
  ds_read_b64_tr_b16 v[38:39], v15 offset:3200
  ds_read_b64_tr_b16 v[40:41], v15 offset:4096
  ds_read_b64_tr_b16 v[42:43], v15 offset:4224
  ds_read_b64_tr_b16 v[44:45], v15 offset:5120
  ds_read_b64_tr_b16 v[46:47], v15 offset:5248
  ds_read_b64_tr_b16 v[48:49], v15 offset:6144
  ds_read_b64_tr_b16 v[50:51], v15 offset:6272
  ds_read_b64_tr_b16 v[52:53], v15 offset:7168
  ds_read_b64_tr_b16 v[54:55], v15 offset:7296
  ds_read_b64_tr_b16 v[56:57], v15 offset:8192
  ds_read_b64_tr_b16 v[58:59], v15 offset:8320
  ds_read_b64_tr_b16 v[60:61], v15 offset:9216
  ds_read_b64_tr_b16 v[62:63], v15 offset:9344
  ds_read_b64_tr_b16 v[64:65], v15 offset:10240
  ds_read_b64_tr_b16 v[66:67], v15 offset:10368
  ds_read_b64_tr_b16 v[68:69], v15 offset:11264
  ds_read_b64_tr_b16 v[70:71], v15 offset:11392
  ds_read_b64_tr_b16 v[72:73], v15 offset:12288
  ds_read_b64_tr_b16 v[74:75], v15 offset:12416
  ds_read_b64_tr_b16 v[76:77], v15 offset:13312
  ds_read_b64_tr_b16 v[78:79], v15 offset:13440
  v_mov_b32 v80, s96
  v_mov_b32 v16, 0
  v_mov_b32 v81, s96
  v_mov_b32 v17, 0
  v_mov_b32 v82, s96
  v_mov_b32 v18, 0
  v_mov_b32 v83, s96
  v_mov_b32 v19, 0
  s_waitcnt lgkmcnt(15)
  s_nop 0
  v_smfmac_f32_16x16x64_bf16 v[16:19], v[80:83], v[24:31], v8
  v_smfmac_f32_16x16x64_bf16 v[16:19], v[80:83], v[32:39], v8
  s_waitcnt lgkmcnt(12)
  v_smfmac_f32_16x16x64_bf16 v[16:19], v[80:83], v[40:47], v8
  v_smfmac_f32_16x16x64_bf16 v[16:19], v[80:83], v[48:55], v8
  s_waitcnt lgkmcnt(4)
  v_smfmac_f32_16x16x64_bf16 v[16:19], v[80:83], v[56:63], v8
  v_smfmac_f32_16x16x64_bf16 v[16:19], v[80:83], v[64:71], v8
  s_waitcnt lgkmcnt(0)
  v_smfmac_f32_16x16x64_bf16 v[16:19], v[80:83], v[72:79], v8
  v_mov_b32 v92, 0
  v_mov_b32 v93, 0
  v_mov_b32 v94, 0
  v_mov_b32 v95, 0
  s_lshl_b32 s98, s6, 10
  s_lshl_b32 s99, s7, 5
  s_add_u32 s98, s98, s99
  v_bfe_u32 v15, v0, 1, 1
  v_lshlrev_b32 v15, 4, v15
  v_bfe_u32 v23, v0, 2, 2
  v_lshl_add_u32 v15, v23, 2, v15
  v_add_u32 v15, s98, v15
  v_add_f32 v16, v16, v17
  s_cmp_eq_u32 s51, 0
  s_cbranch_scc1 L_s7nopoll_11
  v_mov_b32 v96, 0
  v_mov_b32 v97, 0
  v_mov_b32 v98, 0
  v_mov_b32 v99, 0
  v_mov_b32 v100, 0
  v_mov_b32 v101, 0
  v_mov_b32 v102, 0
  v_mov_b32 v103, 0
  s_cmp_ge_u32 s5, 28
  s_cbranch_scc1 L_tokok_13
  s_lshl_b32 s99, s51, 3
  s_sub_u32 s99, s99, 2
  v_mov_b32 v22, 163136
  L_tok_12:
  ds_read_b32 v23, v22
  s_waitcnt lgkmcnt(0)
  v_readfirstlane_b32 s98, v23
  s_nop 0
  s_cmp_ge_u32 s98, s99
  s_cbranch_scc1 L_tokok_13
  s_sub_u32 s53, s53, 1
  s_cmp_gt_i32 s53, 0
  s_cbranch_scc1 L_tok_12
  L_tokok_13:
  s_mov_b64 exec, s[92:93]
  L_poll_14:
  buffer_load_dwordx4 v[96:99], v12, s[40:43], 0 offen sc1
  buffer_load_dwordx4 v[100:103], v12, s[40:43], 0 offen offset:16 sc1
  s_waitcnt vmcnt(0)
  v_max_u32 v80, v96, v97
  v_max3_u32 v80, v98, v99, v80
  v_max3_u32 v80, v100, v101, v80
  v_max3_u32 v80, v102, v103, v80
  v_cmp_eq_u32 vcc, -1, v80
  s_nop 0
  s_cbranch_vccnz L_retry_16
  L_pollok_15:
  L_s7nopoll_11:
  s_mov_b64 exec, s[92:93]
  ds_write_b128 v13, v[96:99]
  ds_write_b128 v13, v[100:103] offset:16
  s_mov_b64 exec, -1
  ds_read_b128 v[80:83], v14 offset:0
  ds_read_b128 v[84:87], v14 offset:128
  ds_read_b128 v[88:91], v14 offset:256
  v_mov_b32 v12, 0
  v_mov_b32 v23, 0
  v_dot2c_f32_bf16 v12, s96, v96
  v_dot2c_f32_bf16 v23, v96, v96
  v_dot2c_f32_bf16 v12, s96, v97
  v_dot2c_f32_bf16 v23, v97, v97
  v_dot2c_f32_bf16 v12, s96, v98
  v_dot2c_f32_bf16 v23, v98, v98
  v_dot2c_f32_bf16 v12, s96, v99
  v_dot2c_f32_bf16 v23, v99, v99
  v_dot2c_f32_bf16 v12, s96, v100
  v_dot2c_f32_bf16 v23, v100, v100
  v_dot2c_f32_bf16 v12, s96, v101
  v_dot2c_f32_bf16 v23, v101, v101
  v_dot2c_f32_bf16 v12, s96, v102
  v_dot2c_f32_bf16 v23, v102, v102
  v_dot2c_f32_bf16 v12, s96, v103
  v_dot2c_f32_bf16 v23, v103, v103
  s_waitcnt lgkmcnt(2)
  v_smfmac_f32_16x16x64_bf16 v[92:95], v[80:83], v[24:31], v8
  ds_read_b128 v[80:83], v14 offset:384
  v_add_f32_dpp v12, v12, v12 quad_perm:[2,3,0,1] row_mask:0xf bank_mask:0xf
  v_add_f32_dpp v23, v23, v23 quad_perm:[2,3,0,1] row_mask:0xf bank_mask:0xf
  s_waitcnt lgkmcnt(2)
  v_smfmac_f32_16x16x64_bf16 v[92:95], v[84:87], v[32:39], v8
  ds_read_b128 v[84:87], v14 offset:512
  v_add_f32_dpp v12, v12, v12 row_ror:4 row_mask:0xf bank_mask:0xf
  v_add_f32_dpp v23, v23, v23 row_ror:4 row_mask:0xf bank_mask:0xf
  s_waitcnt lgkmcnt(2)
  v_smfmac_f32_16x16x64_bf16 v[92:95], v[88:91], v[40:47], v8
  ds_read_b128 v[88:91], v14 offset:640
  v_add_f32_dpp v12, v12, v12 row_ror:8 row_mask:0xf bank_mask:0xf
  v_add_f32_dpp v23, v23, v23 row_ror:8 row_mask:0xf bank_mask:0xf
  s_waitcnt lgkmcnt(2)
  v_smfmac_f32_16x16x64_bf16 v[92:95], v[80:83], v[48:55], v8
  ds_read_b128 v[80:83], v14 offset:768
  v_permlane16_swap_b32 v12, v23
  s_waitcnt lgkmcnt(2)
  v_smfmac_f32_16x16x64_bf16 v[92:95], v[84:87], v[56:63], v8
  v_add_f32 v12, v12, v23
  v_mov_b32 v23, v12
  s_waitcnt lgkmcnt(1)
  v_smfmac_f32_16x16x64_bf16 v[92:95], v[88:91], v[64:71], v8
  v_permlane32_swap_b32 v12, v23
  s_waitcnt lgkmcnt(0)
  v_smfmac_f32_16x16x64_bf16 v[92:95], v[80:83], v[72:79], v8
  v_add_f32 v12, v12, v23
  v_mov_b32 v23, v12
  s_nop 1
  v_permlane16_swap_b32 v12, v23
  s_nop 0
  v_mul_f32 v12, 0x3b124925, v12
  v_mul_f32 v23, 0x3b124925, v23
  v_fma_f32 v23, -v12, v12, v23
  v_add_f32 v23, 0x3727c5ac, v23
  v_rsq_f32 v23, v23
  s_nop 0
  v_mul_f32 v12, v12, v23
  v_mov_b32_dpp v96, v23 quad_perm:[0,0,2,2] row_mask:0xf bank_mask:0xf
  v_mov_b32_dpp v97, v23 quad_perm:[1,1,3,3] row_mask:0xf bank_mask:0xf
  v_mov_b32_dpp v98, v12 quad_perm:[0,0,2,2] row_mask:0xf bank_mask:0xf
  v_mov_b32_dpp v99, v12 quad_perm:[1,1,3,3] row_mask:0xf bank_mask:0xf
  v_mul_f32 v98, v98, v16
  v_mul_f32 v99, v99, v16
  s_cmp_eq_u32 s51, 0
  s_cbranch_scc1 L_tqe_17
  s_lshl_b32 s98, s51, 3
  s_sub_u32 s98, s98, 1
  v_mov_b32 v12, s98
  v_mov_b32 v22, 163136
  ds_max_u32 v22, v12
  L_tqe_17:
  v_add_f32 v100, v92, v93
  v_add_f32 v101, v94, v95
  v_fma_f32 v100, v100, v96, -v98
  v_fma_f32 v101, v101, v97, -v99
  s_nop 0
  v_mov_b32_dpp v102, v100 quad_perm:[1,0,3,2] row_mask:0xf bank_mask:0xf
  v_mov_b32_dpp v103, v101 quad_perm:[1,0,3,2] row_mask:0xf bank_mask:0xf
  v_cvt_pk_bf16_f32 v100, v100, v102
  v_cvt_pk_bf16_f32 v101, v101, v103
  s_mov_b64 exec, 0x5555
  s_mul_i32 s98, s51, 327680
  s_cmp_eq_u32 s52, 0
  s_cbranch_scc1 L_pubslow_18
  buffer_store_dword v100, v15, s[8:11], s98 offen
  L_pubdone_19:
  s_cmp_eq_u32 s52, 0
  s_cbranch_scc1 L_pubslow_20
  buffer_store_dword v101, v15, s[8:11], s98 offen offset:512
  L_pubdone_21:
  s_mov_b64 exec, -1
  L_ns7_7:
  s_cmp_eq_u32 s51, 0
  s_cbranch_scc0 L_l1q_22
  s_mul_i32 s99, s6, 229376
  s_lshl_b32 s98, s7, 6
  s_add_u32 s99, s99, s98
  v_lshrrev_b32 v22, 2, v0
  v_mul_u32_u24 v22, 896, v22
  v_and_b32 v23, 3, v0
  v_lshl_add_u32 v22, v23, 4, v22
  v_add_u32 v22, s99, v22
  s_mul_i32 s99, s4, 448
  s_lshl_b32 s98, s5, 4
  s_add_u32 s99, s99, s98
  v_mul_u32_u24 v254, 3584, v0
  v_add_u32 v254, s99, v254
  s_mul_i32 s99, s4, 200704
  s_lshl_b32 s98, s5, 5
  s_add_u32 s99, s99, s98
  v_lshrrev_b32 v255, 1, v0
  v_mul_u32_u24 v255, 896, v255
  v_and_b32 v23, 1, v0
  v_lshl_add_u32 v255, v23, 4, v255
  v_add_u32 v255, s99, v255
  s_cmp_eq_u32 s3, 0
  s_cselect_b32 s1, 4, 3
  s_waitcnt lgkmcnt(0)
  s_add_u32 m0, s0, 8192
  s_nop 0
  buffer_load_dwordx4 v248, s[12:15], s60 offen offset:0 nt lds
  buffer_load_dwordx4 v249, s[12:15], s60 offen offset:1024 nt lds
  buffer_load_dwordx4 v248, s[12:15], s60 offen offset:2048 nt lds
  buffer_load_dwordx4 v249, s[12:15], s60 offen offset:3072 nt lds
  s_add_u32 m0, s0, 12288
  s_add_u32 s98, s60, 4096
  buffer_load_dwordx4 v248, s[12:15], s98 offen offset:0 nt lds
  buffer_load_dwordx4 v249, s[12:15], s98 offen offset:1024 nt lds
  buffer_load_dwordx4 v248, s[12:15], s98 offen offset:2048 nt lds
  buffer_load_dwordx4 v249, s[12:15], s98 offen offset:3072 nt lds
  s_add_u32 s99, s3, 0
  s_mul_i32 s98, s99, 14336
  s_mul_i32 s99, s99, 1024
  s_add_u32 m0, s99, 106496
  s_nop 0
  buffer_load_dwordx4 v22, s[24:27], s98 offen  lds
  s_add_u32 s99, s3, 4
  s_mul_i32 s98, s99, 14336
  s_mul_i32 s99, s99, 1024
  s_add_u32 m0, s99, 106496
  s_nop 0
  buffer_load_dwordx4 v22, s[24:27], s98 offen  lds
  s_waitcnt vmcnt(10)
  ds_read_b128 a[96:99], v250 offset:0
  ds_read_b128 a[100:103], v251 offset:0
  ds_read_b128 a[104:107], v252 offset:0
  ds_read_b128 a[108:111], v253 offset:0
  ds_read_b128 a[112:115], v250 offset:256
  ds_read_b128 a[116:119], v251 offset:256
  ds_read_b128 a[120:123], v252 offset:256
  ds_read_b128 a[124:127], v253 offset:256
  s_waitcnt lgkmcnt(0)
  s_add_u32 m0, s0, 16384
  s_nop 0
  buffer_load_dwordx4 v248, s[12:15], s61 offen offset:0 nt lds
  buffer_load_dwordx4 v249, s[12:15], s61 offen offset:1024 nt lds
  buffer_load_dwordx4 v248, s[12:15], s61 offen offset:2048 nt lds
  buffer_load_dwordx4 v249, s[12:15], s61 offen offset:3072 nt lds
  s_add_u32 m0, s0, 20480
  s_add_u32 s98, s61, 4096
  buffer_load_dwordx4 v248, s[12:15], s98 offen offset:0 nt lds
  buffer_load_dwordx4 v249, s[12:15], s98 offen offset:1024 nt lds
  buffer_load_dwordx4 v248, s[12:15], s98 offen offset:2048 nt lds
  buffer_load_dwordx4 v249, s[12:15], s98 offen offset:3072 nt lds
  s_add_u32 s99, s3, 8
  s_mul_i32 s98, s99, 14336
  s_mul_i32 s99, s99, 1024
  s_add_u32 m0, s99, 106496
  s_nop 0
  buffer_load_dwordx4 v22, s[24:27], s98 offen  lds
  s_add_u32 s99, s3, 12
  s_mul_i32 s98, s99, 14336
  s_mul_i32 s99, s99, 1024
  s_add_u32 m0, s99, 106496
  s_nop 0
  buffer_load_dwordx4 v22, s[24:27], s98 offen  lds
  s_waitcnt vmcnt(12)
  ds_read_b128 a[128:131], v250 offset:8192
  ds_read_b128 a[132:135], v251 offset:8192
  ds_read_b128 a[136:139], v252 offset:8192
  ds_read_b128 a[140:143], v253 offset:8192
  ds_read_b128 a[144:147], v250 offset:8448
  ds_read_b128 a[148:151], v251 offset:8448
  ds_read_b128 a[152:155], v252 offset:8448
  ds_read_b128 a[156:159], v253 offset:8448
  s_cmp_eq_u32 s3, 1
  s_cbranch_scc0 L_nofl_25
  s_lshl_b32 s98, s4, 5
  s_add_u32 s98, s98, s5
  s_and_b32 s99, s98, 3
  s_lshl_b32 s99, s99, 3
  s_lshl_b32 s99, s54, s99
  s_and_b32 s98, s98, 0xFC
  v_mov_b32 v13, s98
  v_mov_b32 v15, s99
  s_mov_b64 exec, 1
  global_atomic_or v13, v15, s[48:49] sc1
  s_mov_b64 exec, -1
  L_nofl_25:
  s_waitcnt lgkmcnt(0)
  s_add_u32 m0, s0, 0
  s_nop 0
  buffer_load_dwordx4 v248, s[12:15], s62 offen offset:0 nt lds
  buffer_load_dwordx4 v249, s[12:15], s62 offen offset:1024 nt lds
  buffer_load_dwordx4 v248, s[12:15], s62 offen offset:2048 nt lds
  buffer_load_dwordx4 v249, s[12:15], s62 offen offset:3072 nt lds
  s_add_u32 m0, s0, 4096
  s_add_u32 s98, s62, 4096
  buffer_load_dwordx4 v248, s[12:15], s98 offen offset:0 nt lds
  buffer_load_dwordx4 v249, s[12:15], s98 offen offset:1024 nt lds
  buffer_load_dwordx4 v248, s[12:15], s98 offen offset:2048 nt lds
  buffer_load_dwordx4 v249, s[12:15], s98 offen offset:3072 nt lds
  s_mov_b32 s99, s3
  s_mul_i32 s98, s99, 229376
  s_mul_i32 s99, s99, 1024
  s_add_u32 m0, s99, 137216
  s_nop 0
  buffer_load_dwordx4 v254, s[28:31], s98 offen  lds
  s_add_u32 s99, s3, s1
  s_cmp_eq_u32 s3, 1
  s_cbranch_scc1 L_tdm_26
  s_mul_i32 s98, s99, 229376
  s_mul_i32 s99, s99, 1024
  s_add_u32 m0, s99, 137216
  s_nop 0
  buffer_load_dwordx4 v254, s[28:31], s98 offen  lds
  L_tdn_27:
  s_waitcnt vmcnt(12)
  ds_read_b128 a[160:163], v250 offset:16384
  ds_read_b128 a[164:167], v251 offset:16384
  ds_read_b128 a[168:171], v252 offset:16384
  ds_read_b128 a[172:175], v253 offset:16384
  ds_read_b128 a[176:179], v250 offset:16640
  ds_read_b128 a[180:183], v251 offset:16640
  ds_read_b128 a[184:187], v252 offset:16640
  ds_read_b128 a[188:191], v253 offset:16640
  s_waitcnt lgkmcnt(0)
  s_add_u32 m0, s0, 8192
  s_nop 0
  buffer_load_dwordx4 v248, s[12:15], s63 offen offset:0 nt lds
  buffer_load_dwordx4 v249, s[12:15], s63 offen offset:1024 nt lds
  buffer_load_dwordx4 v248, s[12:15], s63 offen offset:2048 nt lds
  buffer_load_dwordx4 v249, s[12:15], s63 offen offset:3072 nt lds
  s_add_u32 m0, s0, 12288
  s_add_u32 s98, s63, 4096
  buffer_load_dwordx4 v248, s[12:15], s98 offen offset:0 nt lds
  buffer_load_dwordx4 v249, s[12:15], s98 offen offset:1024 nt lds
  buffer_load_dwordx4 v248, s[12:15], s98 offen offset:2048 nt lds
  buffer_load_dwordx4 v249, s[12:15], s98 offen offset:3072 nt lds
  s_mov_b32 s99, s3
  s_mul_i32 s98, s99, 229376
  s_mul_i32 s99, s99, 1024
  s_add_u32 m0, s99, 144384
  s_nop 0
  buffer_load_dwordx4 v254, s[32:35], s98 offen  lds
  s_add_u32 s99, s3, s1
  s_cmp_eq_u32 s3, 1
  s_cbranch_scc1 L_tdm_28
  s_mul_i32 s98, s99, 229376
  s_mul_i32 s99, s99, 1024
  s_add_u32 m0, s99, 144384
  s_nop 0
  buffer_load_dwordx4 v254, s[32:35], s98 offen  lds
  L_tdn_29:
  s_waitcnt vmcnt(12)
  ds_read_b128 a[192:195], v250 offset:0
  ds_read_b128 a[196:199], v251 offset:0
  ds_read_b128 a[200:203], v252 offset:0
  ds_read_b128 a[204:207], v253 offset:0
  ds_read_b128 a[208:211], v250 offset:256
  ds_read_b128 a[212:215], v251 offset:256
  ds_read_b128 a[216:219], v252 offset:256
  ds_read_b128 a[220:223], v253 offset:256
  s_mov_b32 s99, s3
  s_mul_i32 s98, s99, 28672
  s_mul_i32 s99, s99, 1024
  s_add_u32 m0, s99, 151552
  s_nop 0
  buffer_load_dwordx4 v255, s[36:39], s98 offen  lds
  s_add_u32 s99, s3, s1
  s_cmp_eq_u32 s3, 1
  s_cbranch_scc1 L_tdm_30
  s_mul_i32 s98, s99, 28672
  s_mul_i32 s99, s99, 1024
  s_add_u32 m0, s99, 151552
  s_nop 0
  buffer_load_dwordx4 v255, s[36:39], s98 offen  lds
  L_tdn_31:
  buffer_load_dwordx4 v[104:107], v20, s[16:19], s56 offen offset:0 nt
  buffer_load_dwordx4 v[108:111], v20, s[16:19], s56 offen offset:256 nt
  buffer_load_dwordx4 v[112:115], v20, s[16:19], s56 offen offset:2048 nt
  buffer_load_dwordx4 v[116:119], v20, s[16:19], s56 offen offset:2304 nt
  buffer_load_dwordx4 v[120:123], v21, s[16:19], s56 offen offset:0 nt
  buffer_load_dwordx4 v[124:127], v21, s[16:19], s56 offen offset:256 nt
  s_waitcnt vmcnt(10)
  ds_read_b128 a[224:227], v250 offset:8192
  ds_read_b128 a[228:231], v251 offset:8192
  ds_read_b128 a[232:235], v252 offset:8192
  ds_read_b128 a[236:239], v253 offset:8192
  ds_read_b128 a[240:243], v250 offset:8448
  ds_read_b128 a[244:247], v251 offset:8448
  ds_read_b128 a[248:251], v252 offset:8448
  ds_read_b128 a[252:255], v253 offset:8448
  s_waitcnt lgkmcnt(0)
  s_add_u32 s98, s56, 2048
  s_add_u32 m0, s0, 0
  s_nop 0
  buffer_load_dwordx4 v21, s[16:19], s98 offen nt lds
  s_add_u32 s98, s56, 2304
  s_add_u32 m0, s0, 1024
  s_nop 0
  buffer_load_dwordx4 v21, s[16:19], s98 offen nt lds
  buffer_load_dwordx4 v[128:131], v20, s[16:19], s57 offen offset:0 nt
  buffer_load_dwordx4 v[132:135], v20, s[16:19], s57 offen offset:256 nt
  s_add_u32 s98, s57, 2048
  s_add_u32 m0, s0, 2048
  s_nop 0
  buffer_load_dwordx4 v20, s[16:19], s98 offen nt lds
  s_add_u32 s98, s57, 2304
  s_add_u32 m0, s0, 3072
  s_nop 0
  buffer_load_dwordx4 v20, s[16:19], s98 offen nt lds
  buffer_load_dwordx4 v[136:139], v21, s[16:19], s57 offen offset:0 nt
  buffer_load_dwordx4 v[140:143], v21, s[16:19], s57 offen offset:256 nt
  s_add_u32 s98, s57, 2048
  s_add_u32 m0, s0, 4096
  s_nop 0
  buffer_load_dwordx4 v21, s[16:19], s98 offen nt lds
  s_add_u32 s98, s57, 2304
  s_add_u32 m0, s0, 5120
  s_nop 0
  buffer_load_dwordx4 v21, s[16:19], s98 offen nt lds
  s_waitcnt vmcnt(14)
  buffer_load_dwordx4 v[144:147], v20, s[16:19], s58 offen offset:0 nt
  buffer_load_dwordx4 v[148:151], v20, s[16:19], s58 offen offset:256 nt
  s_waitcnt vmcnt(14)
  s_add_u32 s98, s58, 2048
  s_add_u32 m0, s0, 6144
  s_nop 0
  buffer_load_dwordx4 v20, s[16:19], s98 offen nt lds
  s_add_u32 s98, s58, 2304
  s_add_u32 m0, s0, 7168
  s_nop 0
  buffer_load_dwordx4 v20, s[16:19], s98 offen nt lds
  s_waitcnt vmcnt(14)
  buffer_load_dwordx4 v[152:155], v21, s[16:19], s58 offen offset:0 nt
  buffer_load_dwordx4 v[156:159], v21, s[16:19], s58 offen offset:256 nt
  s_waitcnt vmcnt(14)
  s_add_u32 s98, s58, 2048
  s_add_u32 m0, s0, 8192
  s_nop 0
  buffer_load_dwordx4 v21, s[16:19], s98 offen nt lds
  s_add_u32 s98, s58, 2304
  s_add_u32 m0, s0, 9216
  s_nop 0
  buffer_load_dwordx4 v21, s[16:19], s98 offen nt lds
  v_lshlrev_b32 v12, 2, v0
  global_load_dword v94, v12, s[48:49] sc1
  buffer_load_dwordx4 v[160:163], v20, s[16:19], s59 offen offset:0 nt
  buffer_load_dwordx4 v[164:167], v20, s[16:19], s59 offen offset:256 nt
  s_add_u32 s98, s59, 2048
  s_add_u32 m0, s0, 10240
  s_nop 0
  buffer_load_dwordx4 v20, s[16:19], s98 offen nt lds
  s_add_u32 s98, s59, 2304
  s_add_u32 m0, s0, 11264
  s_nop 0
  buffer_load_dwordx4 v20, s[16:19], s98 offen nt lds
  buffer_load_dwordx4 v[168:171], v21, s[16:19], s59 offen offset:0 nt
  buffer_load_dwordx4 v[172:175], v21, s[16:19], s59 offen offset:256 nt
  s_add_u32 s98, s59, 2048
  s_add_u32 m0, s0, 12288
  s_nop 0
  buffer_load_dwordx4 v21, s[16:19], s98 offen nt lds
  s_add_u32 s98, s59, 2304
  s_add_u32 m0, s0, 13312
  s_nop 0
  buffer_load_dwordx4 v21, s[16:19], s98 offen nt lds
  s_lshl_b32 s98, s3, 10
  s_add_u32 s98, s98, 158720
  v_lshlrev_b32 v14, 5, v1
  v_and_b32 v15, 1, v2
  v_lshl_add_u32 v14, v15, 4, v14
  v_lshrrev_b32 v15, 1, v2
  v_lshl_add_u32 v14, v15, 9, v14
  v_add_u32 v14, s98, v14
  s_lshl_b32 s98, s3, 3
  s_add_u32 s98, s98, 162816
  v_mov_b32 v15, s98
  v_lshlrev_b32 v16, 4, v0
  v_add_u32 v16, 158720, v16
  v_mov_b32 v17, 162816
  s_lshl_b32 s98, s6, 13
  s_lshl_b32 s99, s7, 9
  s_add_u32 s98, s98, s99
  s_add_u32 s98, s98, 16384
  v_lshlrev_b32 v18, 3, v0
  v_add_u32 v18, s98, v18
  s_lshl_b32 s98, s6, 7
  s_lshl_b32 s99, s7, 3
  s_add_u32 s98, s98, s99
  s_add_u32 s98, s98, 147456
  v_mov_b32 v19, s98
  s_mul_i32 s98, s3, 26624
  v_lshlrev_b32 v13, 4, v0
  v_add_u32 v13, s98, v13
  s_lshl_b32 s98, s6, 10
  s_lshl_b32 s99, s55, 9
  s_add_u32 s98, s98, s99
  v_lshlrev_b32 v100, 4, v0
  v_add_u32 v100, s98, v100
  v_mov_b32 v101, 2130706432
  v_cmp_gt_u32 vcc, 32, v0
  s_nop 1
  v_cndmask_b32 v100, v101, v100, vcc
  s_waitcnt vmcnt(8)
  v_lshlrev_b32 v11, 16, v11
  L_fchk_32:
  v_and_b32 v95, 0x80808080, v94
  v_cmp_ne_u32 vcc, 0x80808080, v95
  s_nop 0
  s_cbranch_vccz L_fok_33
  global_load_dword v94, v12, s[48:49] sc1
  s_waitcnt vmcnt(0)
  s_sub_u32 s53, s53, 1
  s_cmp_gt_i32 s53, 0
  s_cbranch_scc1 L_fchk_32
  L_fok_33:
  s_mul_i32 s98, s54, 0x01010101
  v_cmp_eq_u32 vcc, s98, v94
  s_lshl_b32 s99, s4, 3
  s_lshr_b64 s[98:99], vcc, s99
  s_and_b32 s98, s98, 0xFF
  s_cmp_eq_u32 s98, 0xFF
  s_cselect_b32 s52, 1, 0
  s_mov_b32 s54, 0
  buffer_load_dwordx4 v[24:27], v10, s[8:11], s50 offen offset:0 sc1
  buffer_load_dwordx4 v[28:31], v10, s[8:11], s50 offen offset:128 sc1
  buffer_load_dwordx4 v[32:35], v10, s[8:11], s50 offen offset:256 sc1
  buffer_load_dwordx4 v[36:39], v10, s[8:11], s50 offen offset:384 sc1
  buffer_load_dwordx4 v[176:179], v20, s[16:19], s60 offen offset:0 nt
  buffer_load_dwordx4 v[180:183], v20, s[16:19], s60 offen offset:256 nt
  s_add_u32 s98, s60, 2048
  s_add_u32 m0, s0, 14336
  s_nop 0
  buffer_load_dwordx4 v20, s[16:19], s98 offen nt lds
  s_add_u32 s98, s60, 2304
  s_add_u32 m0, s0, 15360
  s_nop 0
  buffer_load_dwordx4 v20, s[16:19], s98 offen nt lds
  buffer_load_dwordx4 v[184:187], v21, s[16:19], s60 offen offset:0 nt
  buffer_load_dwordx4 v[188:191], v21, s[16:19], s60 offen offset:256 nt
  s_add_u32 s98, s60, 2048
  s_add_u32 m0, s0, 16384
  s_nop 0
  buffer_load_dwordx4 v21, s[16:19], s98 offen nt lds
  s_add_u32 s98, s60, 2304
  s_add_u32 m0, s0, 17408
  s_nop 0
  buffer_load_dwordx4 v21, s[16:19], s98 offen nt lds
  buffer_load_dwordx4 v[192:195], v20, s[16:19], s61 offen offset:0 nt
  buffer_load_dwordx4 v[196:199], v20, s[16:19], s61 offen offset:256 nt
  s_add_u32 s98, s61, 2048
  s_add_u32 m0, s0, 18432
  s_nop 0
  buffer_load_dwordx4 v20, s[16:19], s98 offen nt lds
  s_add_u32 s98, s61, 2304
  s_add_u32 m0, s0, 19456
  s_nop 0
  buffer_load_dwordx4 v20, s[16:19], s98 offen nt lds
  s_waitcnt vmcnt(12)
  v_max_u32 v102, v24, v25
  v_max3_u32 v102, v26, v27, v102
  v_max3_u32 v102, v28, v29, v102
  v_max3_u32 v102, v30, v31, v102
  v_max3_u32 v102, v32, v33, v102
  v_max3_u32 v102, v34, v35, v102
  v_max3_u32 v102, v36, v37, v102
  v_max3_u32 v102, v38, v39, v102
  v_cmp_eq_u32 vcc, -1, v102
  s_nop 0
  s_cbranch_vccz L_att_23
  s_branch L_l1b_24
  L_l1q_22:
  s_lshl_b32 s98, s3, 10
  s_add_u32 s98, s98, 158720
  v_lshlrev_b32 v14, 5, v1
  v_and_b32 v15, 1, v2
  v_lshl_add_u32 v14, v15, 4, v14
  v_lshrrev_b32 v15, 1, v2
  v_lshl_add_u32 v14, v15, 9, v14
  v_add_u32 v14, s98, v14
  s_lshl_b32 s98, s3, 3
  s_add_u32 s98, s98, 162816
  v_mov_b32 v15, s98
  v_lshlrev_b32 v16, 4, v0
  v_add_u32 v16, 158720, v16
  v_mov_b32 v17, 162816
  s_lshl_b32 s98, s6, 13
  s_lshl_b32 s99, s7, 9
  s_add_u32 s98, s98, s99
  s_add_u32 s98, s98, 16384
  v_lshlrev_b32 v18, 3, v0
  v_add_u32 v18, s98, v18
  s_lshl_b32 s98, s6, 7
  s_lshl_b32 s99, s7, 3
  s_add_u32 s98, s98, s99
  s_add_u32 s98, s98, 147456
  v_mov_b32 v19, s98
  s_mul_i32 s98, s3, 26624
  v_lshlrev_b32 v13, 4, v0
  v_add_u32 v13, s98, v13
  s_lshl_b32 s98, s6, 10
  s_lshl_b32 s99, s55, 9
  s_add_u32 s98, s98, s99
  v_lshlrev_b32 v100, 4, v0
  v_add_u32 v100, s98, v100
  v_mov_b32 v101, 2130706432
  v_cmp_gt_u32 vcc, 32, v0
  s_nop 1
  v_cndmask_b32 v100, v101, v100, vcc
  s_waitcnt vmcnt(0)
  s_lshl_b32 s99, s51, 3
  s_sub_u32 s99, s99, 1
  v_mov_b32 v22, 163136
  L_tok_34:
  ds_read_b32 v23, v22
  s_waitcnt lgkmcnt(0)
  v_readfirstlane_b32 s98, v23
  s_nop 0
  s_cmp_ge_u32 s98, s99
  s_cbranch_scc1 L_tokok_35
  s_sub_u32 s53, s53, 1
  s_cmp_gt_i32 s53, 0
  s_cbranch_scc1 L_tok_34
  L_tokok_35:
  L_l1b_24:
  L_poll_36:
  buffer_load_dwordx4 v[24:27], v10, s[8:11], s50 offen offset:0 sc1
  buffer_load_dwordx4 v[28:31], v10, s[8:11], s50 offen offset:128 sc1
  buffer_load_dwordx4 v[32:35], v10, s[8:11], s50 offen offset:256 sc1
  buffer_load_dwordx4 v[36:39], v10, s[8:11], s50 offen offset:384 sc1
  s_waitcnt vmcnt(0)
  v_max_u32 v102, v24, v25
  v_max3_u32 v102, v26, v27, v102
  v_max3_u32 v102, v28, v29, v102
  v_max3_u32 v102, v30, v31, v102
  v_max3_u32 v102, v32, v33, v102
  v_max3_u32 v102, v34, v35, v102
  v_max3_u32 v102, v36, v37, v102
  v_max3_u32 v102, v38, v39, v102
  v_cmp_eq_u32 vcc, -1, v102
  s_nop 0
  s_cbranch_vccnz L_retry_38
  L_pollok_37:
  L_att_23:
  v_mov_b32 v40, 0
  v_mov_b32 v41, 0
  v_mov_b32 v44, 0
  v_mov_b32 v45, 0
  v_mov_b32 v48, 0
  v_mov_b32 v49, 0
  v_smfmac_f32_16x16x64_bf16 v[40:43], v[24:27], a[0:7], v8
  v_smfmac_f32_16x16x64_bf16 v[40:43], v[28:31], a[8:15], v8
  v_smfmac_f32_16x16x64_bf16 v[40:43], v[32:35], a[16:23], v8
  v_smfmac_f32_16x16x64_bf16 v[40:43], v[36:39], a[24:31], v8
  v_smfmac_f32_16x16x64_bf16 v[44:47], v[24:27], a[32:39], v8
  v_smfmac_f32_16x16x64_bf16 v[44:47], v[28:31], a[40:47], v8
  v_smfmac_f32_16x16x64_bf16 v[44:47], v[32:35], a[48:55], v8
  v_smfmac_f32_16x16x64_bf16 v[44:47], v[36:39], a[56:63], v8
  v_smfmac_f32_16x16x64_bf16 v[48:51], v[24:27], a[64:71], v8
  v_smfmac_f32_16x16x64_bf16 v[48:51], v[28:31], a[72:79], v8
  v_smfmac_f32_16x16x64_bf16 v[48:51], v[32:35], a[80:87], v8
  v_smfmac_f32_16x16x64_bf16 v[48:51], v[36:39], a[88:95], v8
  v_add_f32 v52, v40, v41
  v_mov_b32 v40, 0
  v_mov_b32 v41, 0
  s_nop 1
  v_smfmac_f32_16x16x64_bf16 v[40:43], v[24:27], a[96:103], v8
  v_add_f32 v53, v44, v45
  v_smfmac_f32_16x16x64_bf16 v[40:43], v[28:31], a[104:111], v8
  v_mov_b32 v44, 0
  v_smfmac_f32_16x16x64_bf16 v[40:43], v[32:35], a[112:119], v8
  v_mov_b32 v45, 0
  v_smfmac_f32_16x16x64_bf16 v[40:43], v[36:39], a[120:127], v8
  v_add_f32 v54, v48, v49
  v_smfmac_f32_16x16x64_bf16 v[44:47], v[24:27], a[128:135], v8
  v_mov_b32 v48, 0
  v_smfmac_f32_16x16x64_bf16 v[44:47], v[28:31], a[136:143], v8
  v_mov_b32 v49, 0
  v_smfmac_f32_16x16x64_bf16 v[44:47], v[32:35], a[144:151], v8
  v_smfmac_f32_16x16x64_bf16 v[44:47], v[36:39], a[152:159], v8
  v_smfmac_f32_16x16x64_bf16 v[48:51], v[24:27], a[160:167], v8
  v_add_f32 v55, v40, v41
  v_smfmac_f32_16x16x64_bf16 v[48:51], v[28:31], a[168:175], v8
  v_mov_b32 v40, 0
  v_smfmac_f32_16x16x64_bf16 v[48:51], v[32:35], a[176:183], v8
  v_mov_b32 v41, 0
  v_smfmac_f32_16x16x64_bf16 v[48:51], v[36:39], a[184:191], v8
  s_nop 0
  v_smfmac_f32_16x16x64_bf16 v[40:43], v[24:27], a[192:199], v8
  v_add_f32 v56, v44, v45
  v_smfmac_f32_16x16x64_bf16 v[40:43], v[28:31], a[200:207], v8
  v_mov_b32 v44, 0
  v_smfmac_f32_16x16x64_bf16 v[40:43], v[32:35], a[208:215], v8
  v_mov_b32 v45, 0
  v_smfmac_f32_16x16x64_bf16 v[40:43], v[36:39], a[216:223], v8
  s_nop 0
  v_smfmac_f32_16x16x64_bf16 v[44:47], v[24:27], a[224:231], v8
  v_add_f32 v57, v48, v49
  v_smfmac_f32_16x16x64_bf16 v[44:47], v[28:31], a[232:239], v8
  v_smfmac_f32_16x16x64_bf16 v[44:47], v[32:35], a[240:247], v8
  v_smfmac_f32_16x16x64_bf16 v[44:47], v[36:39], a[248:255], v8
  s_nop 1
  v_add_f32 v58, v40, v41
  s_nop 4
  v_add_f32 v59, v44, v45
  v_max3_f32 v81, v52, v53, v54
  v_max3_f32 v82, v55, v56, v57
  v_max3_f32 v81, v58, v59, v81
  v_max_f32 v81, v81, v82
  s_nop 1
  v_max_f32_dpp v81, v81, v81 row_ror:1 row_mask:0xf bank_mask:0xf
  s_nop 1
  v_max_f32_dpp v81, v81, v81 row_ror:2 row_mask:0xf bank_mask:0xf
  s_nop 1
  v_max_f32_dpp v81, v81, v81 row_ror:4 row_mask:0xf bank_mask:0xf
  s_nop 1
  v_max_f32_dpp v81, v81, v81 row_ror:8 row_mask:0xf bank_mask:0xf
  v_mul_f32 v81, s97, v81
  v_fma_f32 v52, v52, s97, -v81
  v_exp_f32 v52, v52
  s_nop 0
  v_cvt_pk_bf16_f32 v60, v52, v52
  v_mov_b32 v80, v52
  s_nop 0
  v_mov_b32_dpp v60, v60 row_shl:1 row_mask:0xa bank_mask:0xf
  s_cmp_eq_u32 s51, 0
  s_cbranch_scc0 L_l0skip_39
  buffer_load_dwordx4 v[200:203], v21, s[16:19], s61 offen offset:0 nt
  buffer_load_dwordx4 v[204:207], v21, s[16:19], s61 offen offset:256 nt
  s_add_u32 s98, s61, 2048
  s_add_u32 m0, s0, 20480
  s_nop 0
  buffer_load_dwordx4 v21, s[16:19], s98 offen nt lds
  s_add_u32 s98, s61, 2304
  s_add_u32 m0, s0, 21504
  s_nop 0
  buffer_load_dwordx4 v21, s[16:19], s98 offen nt lds
  buffer_load_dwordx4 v[208:211], v20, s[16:19], s62 offen offset:0 nt
  buffer_load_dwordx4 v[212:215], v20, s[16:19], s62 offen offset:256 nt
  s_add_u32 s98, s62, 2048
  s_add_u32 m0, s0, 22528
  s_nop 0
  buffer_load_dwordx4 v20, s[16:19], s98 offen nt lds
  s_add_u32 s98, s62, 2304
  s_add_u32 m0, s0, 23552
  s_nop 0
  buffer_load_dwordx4 v20, s[16:19], s98 offen nt lds
  buffer_load_dwordx4 v[216:219], v21, s[16:19], s62 offen offset:0 nt
  buffer_load_dwordx4 v[220:223], v21, s[16:19], s62 offen offset:256 nt
  s_add_u32 s98, s62, 2048
  s_add_u32 m0, s0, 24576
  s_nop 0
  buffer_load_dwordx4 v21, s[16:19], s98 offen nt lds
  s_add_u32 s98, s62, 2304
  s_add_u32 m0, s0, 25600
  s_nop 0
  buffer_load_dwordx4 v21, s[16:19], s98 offen nt lds
  buffer_load_dwordx4 v[224:227], v20, s[16:19], s63 offen offset:0 nt
  buffer_load_dwordx4 v[228:231], v20, s[16:19], s63 offen offset:256 nt
  buffer_load_dwordx4 v[232:235], v20, s[16:19], s63 offen offset:2048 nt
  buffer_load_dwordx4 v[236:239], v20, s[16:19], s63 offen offset:2304 nt
  buffer_load_dwordx4 v[240:243], v21, s[16:19], s63 offen offset:0 nt
  buffer_load_dwordx4 v[244:247], v21, s[16:19], s63 offen offset:256 nt
  buffer_load_dwordx4 v[248:251], v21, s[16:19], s63 offen offset:2048 nt
  buffer_load_dwordx4 v[252:255], v21, s[16:19], s63 offen offset:2304 nt
  L_l0skip_39:
  ds_read_b128 v[92:95], v13 offset:0
  ds_read_b128 v[96:99], v13 offset:1024
  v_mov_b32 v76, 0
  v_mov_b32 v77, 0
  v_mov_b32 v78, 0
  v_mov_b32 v79, 0
  v_and_b32_dpp v84, v60, v4 row_newbcast:0 row_mask:0xf bank_mask:0xf
  v_and_b32_dpp v85, v60, v5 row_newbcast:0 row_mask:0xf bank_mask:0xf
  v_and_b32_dpp v86, v60, v4 row_newbcast:2 row_mask:0xf bank_mask:0xf
  v_and_b32_dpp v87, v60, v5 row_newbcast:2 row_mask:0xf bank_mask:0xf
  ds_read_b128 v[24:27], v13 offset:2048
  ds_read_b128 v[28:31], v13 offset:3072
  v_smfmac_f32_16x16x64_bf16 v[76:79], v[84:87], v[104:111], v9
  v_and_b32_dpp v88, v60, v4 row_newbcast:4 row_mask:0xf bank_mask:0xf
  v_and_b32_dpp v89, v60, v5 row_newbcast:4 row_mask:0xf bank_mask:0xf
  v_and_b32_dpp v90, v60, v4 row_newbcast:6 row_mask:0xf bank_mask:0xf
  v_and_b32_dpp v91, v60, v5 row_newbcast:6 row_mask:0xf bank_mask:0xf
  v_fma_f32 v53, v53, s97, -v81
  v_exp_f32 v53, v53
  v_smfmac_f32_16x16x64_bf16 v[76:79], v[88:91], v[112:119], v9
  v_and_b32_dpp v84, v60, v4 row_newbcast:8 row_mask:0xf bank_mask:0xf
  v_and_b32_dpp v85, v60, v5 row_newbcast:8 row_mask:0xf bank_mask:0xf
  v_and_b32_dpp v86, v60, v4 row_newbcast:10 row_mask:0xf bank_mask:0xf
  v_and_b32_dpp v87, v60, v5 row_newbcast:10 row_mask:0xf bank_mask:0xf
  v_cvt_pk_bf16_f32 v61, v53, v53
  v_add_f32 v80, v80, v53
  ds_read_b128 v[32:35], v13 offset:4096
  ds_read_b128 v[36:39], v13 offset:5120
  v_smfmac_f32_16x16x64_bf16 v[76:79], v[84:87], v[120:127], v9
  v_and_b32_dpp v88, v60, v4 row_newbcast:12 row_mask:0xf bank_mask:0xf
  v_and_b32_dpp v89, v60, v5 row_newbcast:12 row_mask:0xf bank_mask:0xf
  v_and_b32_dpp v90, v60, v4 row_newbcast:14 row_mask:0xf bank_mask:0xf
  v_and_b32_dpp v91, v60, v5 row_newbcast:14 row_mask:0xf bank_mask:0xf
  v_mov_b32_dpp v61, v61 row_shl:1 row_mask:0xa bank_mask:0xf
  s_waitcnt lgkmcnt(4)
  v_smfmac_f32_16x16x64_bf16 v[76:79], v[88:91], v[92:99], v9
  v_and_b32_dpp v84, v61, v4 row_newbcast:0 row_mask:0xf bank_mask:0xf
  v_and_b32_dpp v85, v61, v5 row_newbcast:0 row_mask:0xf bank_mask:0xf
  v_and_b32_dpp v86, v61, v4 row_newbcast:2 row_mask:0xf bank_mask:0xf
  v_and_b32_dpp v87, v61, v5 row_newbcast:2 row_mask:0xf bank_mask:0xf
  ds_read_b128 v[92:95], v13 offset:6144
  ds_read_b128 v[96:99], v13 offset:7168
  v_smfmac_f32_16x16x64_bf16 v[76:79], v[84:87], v[128:135], v9
  v_and_b32_dpp v88, v61, v4 row_newbcast:4 row_mask:0xf bank_mask:0xf
  v_and_b32_dpp v89, v61, v5 row_newbcast:4 row_mask:0xf bank_mask:0xf
  v_and_b32_dpp v90, v61, v4 row_newbcast:6 row_mask:0xf bank_mask:0xf
  v_and_b32_dpp v91, v61, v5 row_newbcast:6 row_mask:0xf bank_mask:0xf
  v_fma_f32 v54, v54, s97, -v81
  v_exp_f32 v54, v54
  s_waitcnt lgkmcnt(4)
  v_smfmac_f32_16x16x64_bf16 v[76:79], v[88:91], v[24:31], v9
  v_and_b32_dpp v84, v61, v4 row_newbcast:8 row_mask:0xf bank_mask:0xf
  v_and_b32_dpp v85, v61, v5 row_newbcast:8 row_mask:0xf bank_mask:0xf
  v_and_b32_dpp v86, v61, v4 row_newbcast:10 row_mask:0xf bank_mask:0xf
  v_and_b32_dpp v87, v61, v5 row_newbcast:10 row_mask:0xf bank_mask:0xf
  v_cvt_pk_bf16_f32 v62, v54, v54
  v_add_f32 v80, v80, v54
  ds_read_b128 v[24:27], v13 offset:8192
  ds_read_b128 v[28:31], v13 offset:9216
  v_smfmac_f32_16x16x64_bf16 v[76:79], v[84:87], v[136:143], v9
  v_and_b32_dpp v88, v61, v4 row_newbcast:12 row_mask:0xf bank_mask:0xf
  v_and_b32_dpp v89, v61, v5 row_newbcast:12 row_mask:0xf bank_mask:0xf
  v_and_b32_dpp v90, v61, v4 row_newbcast:14 row_mask:0xf bank_mask:0xf
  v_and_b32_dpp v91, v61, v5 row_newbcast:14 row_mask:0xf bank_mask:0xf
  v_mov_b32_dpp v62, v62 row_shl:1 row_mask:0xa bank_mask:0xf
  s_waitcnt lgkmcnt(4)
  v_smfmac_f32_16x16x64_bf16 v[76:79], v[88:91], v[32:39], v9
  v_and_b32_dpp v84, v62, v4 row_newbcast:0 row_mask:0xf bank_mask:0xf
  v_and_b32_dpp v85, v62, v5 row_newbcast:0 row_mask:0xf bank_mask:0xf
  v_and_b32_dpp v86, v62, v4 row_newbcast:2 row_mask:0xf bank_mask:0xf
  v_and_b32_dpp v87, v62, v5 row_newbcast:2 row_mask:0xf bank_mask:0xf
  ds_read_b128 v[32:35], v13 offset:10240
  ds_read_b128 v[36:39], v13 offset:11264
  v_smfmac_f32_16x16x64_bf16 v[76:79], v[84:87], v[144:151], v9
  v_and_b32_dpp v88, v62, v4 row_newbcast:4 row_mask:0xf bank_mask:0xf
  v_and_b32_dpp v89, v62, v5 row_newbcast:4 row_mask:0xf bank_mask:0xf
  v_and_b32_dpp v90, v62, v4 row_newbcast:6 row_mask:0xf bank_mask:0xf
  v_and_b32_dpp v91, v62, v5 row_newbcast:6 row_mask:0xf bank_mask:0xf
  v_fma_f32 v55, v55, s97, -v81
  v_exp_f32 v55, v55
  s_waitcnt lgkmcnt(4)
  v_smfmac_f32_16x16x64_bf16 v[76:79], v[88:91], v[92:99], v9
  v_and_b32_dpp v84, v62, v4 row_newbcast:8 row_mask:0xf bank_mask:0xf
  v_and_b32_dpp v85, v62, v5 row_newbcast:8 row_mask:0xf bank_mask:0xf
  v_and_b32_dpp v86, v62, v4 row_newbcast:10 row_mask:0xf bank_mask:0xf
  v_and_b32_dpp v87, v62, v5 row_newbcast:10 row_mask:0xf bank_mask:0xf
  v_cvt_pk_bf16_f32 v63, v55, v55
  v_add_f32 v80, v80, v55
  ds_read_b128 v[92:95], v13 offset:12288
  ds_read_b128 v[96:99], v13 offset:13312
  v_smfmac_f32_16x16x64_bf16 v[76:79], v[84:87], v[152:159], v9
  v_and_b32_dpp v88, v62, v4 row_newbcast:12 row_mask:0xf bank_mask:0xf
  v_and_b32_dpp v89, v62, v5 row_newbcast:12 row_mask:0xf bank_mask:0xf
  v_and_b32_dpp v90, v62, v4 row_newbcast:14 row_mask:0xf bank_mask:0xf
  v_and_b32_dpp v91, v62, v5 row_newbcast:14 row_mask:0xf bank_mask:0xf
  v_mov_b32_dpp v63, v63 row_shl:1 row_mask:0xa bank_mask:0xf
  s_waitcnt lgkmcnt(4)
  v_smfmac_f32_16x16x64_bf16 v[76:79], v[88:91], v[24:31], v9
  v_and_b32_dpp v84, v63, v4 row_newbcast:0 row_mask:0xf bank_mask:0xf
  v_and_b32_dpp v85, v63, v5 row_newbcast:0 row_mask:0xf bank_mask:0xf
  v_and_b32_dpp v86, v63, v4 row_newbcast:2 row_mask:0xf bank_mask:0xf
  v_and_b32_dpp v87, v63, v5 row_newbcast:2 row_mask:0xf bank_mask:0xf
  s_waitcnt vmcnt(28)
  ds_read_b128 v[24:27], v13 offset:14336
  ds_read_b128 v[28:31], v13 offset:15360
  v_smfmac_f32_16x16x64_bf16 v[76:79], v[84:87], v[160:167], v9
  v_and_b32_dpp v88, v63, v4 row_newbcast:4 row_mask:0xf bank_mask:0xf
  v_and_b32_dpp v89, v63, v5 row_newbcast:4 row_mask:0xf bank_mask:0xf
  v_and_b32_dpp v90, v63, v4 row_newbcast:6 row_mask:0xf bank_mask:0xf
  v_and_b32_dpp v91, v63, v5 row_newbcast:6 row_mask:0xf bank_mask:0xf
  v_fma_f32 v56, v56, s97, -v81
  v_exp_f32 v56, v56
  s_waitcnt lgkmcnt(4)
  v_smfmac_f32_16x16x64_bf16 v[76:79], v[88:91], v[32:39], v9
  v_and_b32_dpp v84, v63, v4 row_newbcast:8 row_mask:0xf bank_mask:0xf
  v_and_b32_dpp v85, v63, v5 row_newbcast:8 row_mask:0xf bank_mask:0xf
  v_and_b32_dpp v86, v63, v4 row_newbcast:10 row_mask:0xf bank_mask:0xf
  v_and_b32_dpp v87, v63, v5 row_newbcast:10 row_mask:0xf bank_mask:0xf
  v_cvt_pk_bf16_f32 v64, v56, v56
  v_add_f32 v80, v80, v56
  s_waitcnt vmcnt(24)
  ds_read_b128 v[32:35], v13 offset:16384
  ds_read_b128 v[36:39], v13 offset:17408
  v_smfmac_f32_16x16x64_bf16 v[76:79], v[84:87], v[168:175], v9
  v_and_b32_dpp v88, v63, v4 row_newbcast:12 row_mask:0xf bank_mask:0xf
  v_and_b32_dpp v89, v63, v5 row_newbcast:12 row_mask:0xf bank_mask:0xf
  v_and_b32_dpp v90, v63, v4 row_newbcast:14 row_mask:0xf bank_mask:0xf
  v_and_b32_dpp v91, v63, v5 row_newbcast:14 row_mask:0xf bank_mask:0xf
  v_mov_b32_dpp v64, v64 row_shl:1 row_mask:0xa bank_mask:0xf
  s_waitcnt lgkmcnt(4)
  v_smfmac_f32_16x16x64_bf16 v[76:79], v[88:91], v[92:99], v9
  v_and_b32_dpp v84, v64, v4 row_newbcast:0 row_mask:0xf bank_mask:0xf
  v_and_b32_dpp v85, v64, v5 row_newbcast:0 row_mask:0xf bank_mask:0xf
  v_and_b32_dpp v86, v64, v4 row_newbcast:2 row_mask:0xf bank_mask:0xf
  v_and_b32_dpp v87, v64, v5 row_newbcast:2 row_mask:0xf bank_mask:0xf
  s_waitcnt vmcnt(20)
  ds_read_b128 v[92:95], v13 offset:18432
  ds_read_b128 v[96:99], v13 offset:19456
  v_smfmac_f32_16x16x64_bf16 v[76:79], v[84:87], v[176:183], v9
  v_and_b32_dpp v88, v64, v4 row_newbcast:4 row_mask:0xf bank_mask:0xf
  v_and_b32_dpp v89, v64, v5 row_newbcast:4 row_mask:0xf bank_mask:0xf
  v_and_b32_dpp v90, v64, v4 row_newbcast:6 row_mask:0xf bank_mask:0xf
  v_and_b32_dpp v91, v64, v5 row_newbcast:6 row_mask:0xf bank_mask:0xf
  v_fma_f32 v57, v57, s97, -v81
  v_exp_f32 v57, v57
  s_waitcnt lgkmcnt(4)
  v_smfmac_f32_16x16x64_bf16 v[76:79], v[88:91], v[24:31], v9
  v_and_b32_dpp v84, v64, v4 row_newbcast:8 row_mask:0xf bank_mask:0xf
  v_and_b32_dpp v85, v64, v5 row_newbcast:8 row_mask:0xf bank_mask:0xf
  v_and_b32_dpp v86, v64, v4 row_newbcast:10 row_mask:0xf bank_mask:0xf
  v_and_b32_dpp v87, v64, v5 row_newbcast:10 row_mask:0xf bank_mask:0xf
  v_cvt_pk_bf16_f32 v65, v57, v57
  v_add_f32 v80, v80, v57
  s_waitcnt vmcnt(16)
  ds_read_b128 v[24:27], v13 offset:20480
  ds_read_b128 v[28:31], v13 offset:21504
  v_smfmac_f32_16x16x64_bf16 v[76:79], v[84:87], v[184:191], v9
  v_and_b32_dpp v88, v64, v4 row_newbcast:12 row_mask:0xf bank_mask:0xf
  v_and_b32_dpp v89, v64, v5 row_newbcast:12 row_mask:0xf bank_mask:0xf
  v_and_b32_dpp v90, v64, v4 row_newbcast:14 row_mask:0xf bank_mask:0xf
  v_and_b32_dpp v91, v64, v5 row_newbcast:14 row_mask:0xf bank_mask:0xf
  v_mov_b32_dpp v65, v65 row_shl:1 row_mask:0xa bank_mask:0xf
  s_waitcnt lgkmcnt(4)
  v_smfmac_f32_16x16x64_bf16 v[76:79], v[88:91], v[32:39], v9
  v_and_b32_dpp v84, v65, v4 row_newbcast:0 row_mask:0xf bank_mask:0xf
  v_and_b32_dpp v85, v65, v5 row_newbcast:0 row_mask:0xf bank_mask:0xf
  v_and_b32_dpp v86, v65, v4 row_newbcast:2 row_mask:0xf bank_mask:0xf
  v_and_b32_dpp v87, v65, v5 row_newbcast:2 row_mask:0xf bank_mask:0xf
  s_waitcnt vmcnt(12)
  ds_read_b128 v[32:35], v13 offset:22528
  ds_read_b128 v[36:39], v13 offset:23552
  v_smfmac_f32_16x16x64_bf16 v[76:79], v[84:87], v[192:199], v9
  v_and_b32_dpp v88, v65, v4 row_newbcast:4 row_mask:0xf bank_mask:0xf
  v_and_b32_dpp v89, v65, v5 row_newbcast:4 row_mask:0xf bank_mask:0xf
  v_and_b32_dpp v90, v65, v4 row_newbcast:6 row_mask:0xf bank_mask:0xf
  v_and_b32_dpp v91, v65, v5 row_newbcast:6 row_mask:0xf bank_mask:0xf
  v_fma_f32 v58, v58, s97, -v81
  v_exp_f32 v58, v58
  s_waitcnt lgkmcnt(4)
  v_smfmac_f32_16x16x64_bf16 v[76:79], v[88:91], v[92:99], v9
  v_and_b32_dpp v84, v65, v4 row_newbcast:8 row_mask:0xf bank_mask:0xf
  v_and_b32_dpp v85, v65, v5 row_newbcast:8 row_mask:0xf bank_mask:0xf
  v_and_b32_dpp v86, v65, v4 row_newbcast:10 row_mask:0xf bank_mask:0xf
  v_and_b32_dpp v87, v65, v5 row_newbcast:10 row_mask:0xf bank_mask:0xf
  v_cvt_pk_bf16_f32 v66, v58, v58
  v_add_f32 v80, v80, v58
  s_waitcnt vmcnt(8)
  ds_read_b128 v[92:95], v13 offset:24576
  ds_read_b128 v[96:99], v13 offset:25600
  v_smfmac_f32_16x16x64_bf16 v[76:79], v[84:87], v[200:207], v9
  v_and_b32_dpp v88, v65, v4 row_newbcast:12 row_mask:0xf bank_mask:0xf
  v_and_b32_dpp v89, v65, v5 row_newbcast:12 row_mask:0xf bank_mask:0xf
  v_and_b32_dpp v90, v65, v4 row_newbcast:14 row_mask:0xf bank_mask:0xf
  v_and_b32_dpp v91, v65, v5 row_newbcast:14 row_mask:0xf bank_mask:0xf
  v_mov_b32_dpp v66, v66 row_shl:1 row_mask:0xa bank_mask:0xf
  s_waitcnt lgkmcnt(4)
  v_smfmac_f32_16x16x64_bf16 v[76:79], v[88:91], v[24:31], v9
  v_and_b32_dpp v84, v66, v4 row_newbcast:0 row_mask:0xf bank_mask:0xf
  v_and_b32_dpp v85, v66, v5 row_newbcast:0 row_mask:0xf bank_mask:0xf
  v_and_b32_dpp v86, v66, v4 row_newbcast:2 row_mask:0xf bank_mask:0xf
  v_and_b32_dpp v87, v66, v5 row_newbcast:2 row_mask:0xf bank_mask:0xf
  s_nop 1
  v_smfmac_f32_16x16x64_bf16 v[76:79], v[84:87], v[208:215], v9
  v_and_b32_dpp v88, v66, v4 row_newbcast:4 row_mask:0xf bank_mask:0xf
  v_and_b32_dpp v89, v66, v5 row_newbcast:4 row_mask:0xf bank_mask:0xf
  v_and_b32_dpp v90, v66, v4 row_newbcast:6 row_mask:0xf bank_mask:0xf
  v_and_b32_dpp v91, v66, v5 row_newbcast:6 row_mask:0xf bank_mask:0xf
  v_fma_f32 v59, v59, s97, -v81
  v_exp_f32 v59, v59
  s_waitcnt lgkmcnt(2)
  v_smfmac_f32_16x16x64_bf16 v[76:79], v[88:91], v[32:39], v9
  v_and_b32_dpp v84, v66, v4 row_newbcast:8 row_mask:0xf bank_mask:0xf
  v_and_b32_dpp v85, v66, v5 row_newbcast:8 row_mask:0xf bank_mask:0xf
  v_and_b32_dpp v86, v66, v4 row_newbcast:10 row_mask:0xf bank_mask:0xf
  v_and_b32_dpp v87, v66, v5 row_newbcast:10 row_mask:0xf bank_mask:0xf
  v_cvt_pk_bf16_f32 v67, v59, v59
  v_add_f32 v80, v80, v59
  v_smfmac_f32_16x16x64_bf16 v[76:79], v[84:87], v[216:223], v9
  v_and_b32_dpp v88, v66, v4 row_newbcast:12 row_mask:0xf bank_mask:0xf
  v_and_b32_dpp v89, v66, v5 row_newbcast:12 row_mask:0xf bank_mask:0xf
  v_and_b32_dpp v90, v66, v4 row_newbcast:14 row_mask:0xf bank_mask:0xf
  v_and_b32_dpp v91, v66, v5 row_newbcast:14 row_mask:0xf bank_mask:0xf
  v_mov_b32_dpp v67, v67 row_shl:1 row_mask:0xa bank_mask:0xf
  s_waitcnt lgkmcnt(0)
  v_smfmac_f32_16x16x64_bf16 v[76:79], v[88:91], v[92:99], v9
  v_and_b32_dpp v84, v67, v4 row_newbcast:0 row_mask:0xf bank_mask:0xf
  v_and_b32_dpp v85, v67, v5 row_newbcast:0 row_mask:0xf bank_mask:0xf
  v_and_b32_dpp v86, v67, v4 row_newbcast:2 row_mask:0xf bank_mask:0xf
  v_and_b32_dpp v87, v67, v5 row_newbcast:2 row_mask:0xf bank_mask:0xf
  s_waitcnt vmcnt(6)
  s_nop 0
  v_smfmac_f32_16x16x64_bf16 v[76:79], v[84:87], v[224:231], v9
  v_and_b32_dpp v88, v67, v4 row_newbcast:4 row_mask:0xf bank_mask:0xf
  v_and_b32_dpp v89, v67, v5 row_newbcast:4 row_mask:0xf bank_mask:0xf
  v_and_b32_dpp v90, v67, v4 row_newbcast:6 row_mask:0xf bank_mask:0xf
  v_and_b32_dpp v91, v67, v5 row_newbcast:6 row_mask:0xf bank_mask:0xf
  v_add_f32_dpp v80, v80, v80 row_ror:1 row_mask:0xf bank_mask:0xf
  s_waitcnt vmcnt(4)
  v_smfmac_f32_16x16x64_bf16 v[76:79], v[88:91], v[232:239], v9
  v_and_b32_dpp v84, v67, v4 row_newbcast:8 row_mask:0xf bank_mask:0xf
  v_and_b32_dpp v85, v67, v5 row_newbcast:8 row_mask:0xf bank_mask:0xf
  v_and_b32_dpp v86, v67, v4 row_newbcast:10 row_mask:0xf bank_mask:0xf
  v_and_b32_dpp v87, v67, v5 row_newbcast:10 row_mask:0xf bank_mask:0xf
  v_add_f32_dpp v80, v80, v80 row_ror:2 row_mask:0xf bank_mask:0xf
  s_waitcnt vmcnt(2)
  v_smfmac_f32_16x16x64_bf16 v[76:79], v[84:87], v[240:247], v9
  v_and_b32_dpp v88, v67, v4 row_newbcast:12 row_mask:0xf bank_mask:0xf
  v_and_b32_dpp v89, v67, v5 row_newbcast:12 row_mask:0xf bank_mask:0xf
  v_and_b32_dpp v90, v67, v4 row_newbcast:14 row_mask:0xf bank_mask:0xf
  v_and_b32_dpp v91, v67, v5 row_newbcast:14 row_mask:0xf bank_mask:0xf
  v_add_f32_dpp v80, v80, v80 row_ror:4 row_mask:0xf bank_mask:0xf
  s_waitcnt vmcnt(0)
  v_smfmac_f32_16x16x64_bf16 v[76:79], v[88:91], v[248:255], v9
  v_add_f32_dpp v80, v80, v80 row_ror:8 row_mask:0xf bank_mask:0xf
  s_nop 6
  ds_write_b128 v14, v[76:79]
  ds_write2_b32 v15, v81, v80 offset0:0 offset1:1
  s_waitcnt lgkmcnt(0)
  s_barrier
  s_cmp_eq_u32 s3, 3
  s_cbranch_scc0 L_cw_40
  ds_read_b128 v[40:43], v17
  ds_read_b128 v[44:47], v17 offset:16
  ds_read_b128 v[24:27], v16 offset:0
  ds_read_b128 v[28:31], v16 offset:1024
  ds_read_b128 v[32:35], v16 offset:2048
  ds_read_b128 v[36:39], v16 offset:3072
  s_waitcnt lgkmcnt(4)
  v_max3_f32 v48, v40, v42, v44
  v_max_f32 v48, v48, v46
  v_sub_f32 v40, v40, v48
  v_sub_f32 v42, v42, v48
  v_sub_f32 v44, v44, v48
  v_sub_f32 v46, v46, v48
  v_exp_f32 v40, v40
  v_exp_f32 v42, v42
  v_exp_f32 v44, v44
  v_exp_f32 v46, v46
  s_waitcnt lgkmcnt(0)
  v_mul_f32 v24, v24, v40
  v_mul_f32 v25, v25, v40
  v_mul_f32 v26, v26, v40
  v_mul_f32 v27, v27, v40
  v_mul_f32 v49, v41, v40
  v_fmac_f32 v24, v28, v42
  v_fmac_f32 v25, v29, v42
  v_fmac_f32 v26, v30, v42
  v_fmac_f32 v27, v31, v42
  v_fmac_f32 v49, v43, v42
  v_fmac_f32 v24, v32, v44
  v_fmac_f32 v25, v33, v44
  v_fmac_f32 v26, v34, v44
  v_fmac_f32 v27, v35, v44
  v_fmac_f32 v49, v45, v44
  v_fmac_f32 v24, v36, v46
  v_fmac_f32 v25, v37, v46
  v_fmac_f32 v26, v38, v46
  v_fmac_f32 v27, v39, v46
  v_fmac_f32 v49, v47, v46
  v_cvt_pk_bf16_f32 v28, v24, v25
  v_cvt_pk_bf16_f32 v29, v26, v27
  s_cmp_eq_u32 s52, 0
  s_cbranch_scc1 L_pubslow_45
  buffer_store_dwordx2 v[28:29], v18, s[8:11], s50 offen
  L_pubdone_46:
  s_mov_b64 exec, 1
  s_cmp_eq_u32 s52, 0
  s_cbranch_scc1 L_pubslow_47
  buffer_store_dwordx2 v[48:49], v19, s[8:11], s50 offen
  L_pubdone_48:
  s_mov_b64 exec, -1
  s_lshl_b32 s98, s51, 3
  s_add_u32 s98, s98, 1
  v_mov_b32 v23, s98
  v_mov_b32 v22, 163136
  ds_max_u32 v22, v23
  s_cmp_ge_u32 s5, 28
  s_cbranch_scc1 L_next_44
  s_waitcnt vmcnt(0)
  v_and_b32 v12, 1, v0
  v_mul_u32_u24 v12, 896, v12
  v_lshrrev_b32 v13, 1, v0
  v_lshl_add_u32 v12, v13, 5, v12
  v_add_u32 v13, 158720, v12
  v_bfe_u32 v14, v0, 1, 1
  v_mul_u32_u24 v14, 896, v14
  v_lshl_add_u32 v14, v2, 5, v14
  v_and_b32 v23, 1, v0
  v_lshl_add_u32 v14, v23, 4, v14
  v_add_u32 v14, 158720, v14
  v_lshrrev_b32 v15, 2, v1
  v_lshl_add_u32 v15, v2, 3, v15
  v_lshlrev_b32 v15, 4, v15
  v_and_b32 v23, 1, v0
  v_lshl_add_u32 v15, v23, 3, v15
  v_bfe_u32 v23, v0, 1, 1
  v_mul_u32_u24 v23, 7168, v23
  v_add_u32 v15, v15, v23
  v_add_u32 v15, 137216, v15
  ds_read_b64_tr_b16 v[24:25], v15 offset:0
  ds_read_b64_tr_b16 v[26:27], v15 offset:64
  ds_read_b64_tr_b16 v[28:29], v15 offset:512
  ds_read_b64_tr_b16 v[30:31], v15 offset:576
  ds_read_b64_tr_b16 v[32:33], v15 offset:1024
  ds_read_b64_tr_b16 v[34:35], v15 offset:1088
  ds_read_b64_tr_b16 v[36:37], v15 offset:1536
  ds_read_b64_tr_b16 v[38:39], v15 offset:1600
  ds_read_b64_tr_b16 v[40:41], v15 offset:2048
  ds_read_b64_tr_b16 v[42:43], v15 offset:2112
  ds_read_b64_tr_b16 v[44:45], v15 offset:2560
  ds_read_b64_tr_b16 v[46:47], v15 offset:2624
  ds_read_b64_tr_b16 v[48:49], v15 offset:3072
  ds_read_b64_tr_b16 v[50:51], v15 offset:3136
  ds_read_b64_tr_b16 v[52:53], v15 offset:3584
  ds_read_b64_tr_b16 v[54:55], v15 offset:3648
  ds_read_b64_tr_b16 v[56:57], v15 offset:4096
  ds_read_b64_tr_b16 v[58:59], v15 offset:4160
  ds_read_b64_tr_b16 v[60:61], v15 offset:4608
  ds_read_b64_tr_b16 v[62:63], v15 offset:4672
  ds_read_b64_tr_b16 v[64:65], v15 offset:5120
  ds_read_b64_tr_b16 v[66:67], v15 offset:5184
  ds_read_b64_tr_b16 v[68:69], v15 offset:5632
  ds_read_b64_tr_b16 v[70:71], v15 offset:5696
  ds_read_b64_tr_b16 v[72:73], v15 offset:6144
  ds_read_b64_tr_b16 v[74:75], v15 offset:6208
  ds_read_b64_tr_b16 v[76:77], v15 offset:6656
  ds_read_b64_tr_b16 v[78:79], v15 offset:6720
  v_mov_b32 v80, s96
  v_mov_b32 v16, 0
  v_mov_b32 v81, s96
  v_mov_b32 v17, 0
  v_mov_b32 v82, s96
  v_mov_b32 v18, 0
  v_mov_b32 v83, s96
  v_mov_b32 v19, 0
  s_waitcnt lgkmcnt(15)
  s_nop 0
  v_smfmac_f32_16x16x64_bf16 v[16:19], v[80:83], v[24:31], v8
  v_smfmac_f32_16x16x64_bf16 v[16:19], v[80:83], v[32:39], v8
  s_waitcnt lgkmcnt(12)
  v_smfmac_f32_16x16x64_bf16 v[16:19], v[80:83], v[40:47], v8
  v_smfmac_f32_16x16x64_bf16 v[16:19], v[80:83], v[48:55], v8
  s_waitcnt lgkmcnt(4)
  v_smfmac_f32_16x16x64_bf16 v[16:19], v[80:83], v[56:63], v8
  v_smfmac_f32_16x16x64_bf16 v[16:19], v[80:83], v[64:71], v8
  s_waitcnt lgkmcnt(0)
  v_smfmac_f32_16x16x64_bf16 v[16:19], v[80:83], v[72:79], v8
  v_mov_b32 v92, 0
  v_mov_b32 v93, 0
  v_mov_b32 v94, 0
  v_mov_b32 v95, 0
  s_lshl_b32 s98, s4, 10
  s_lshr_b32 s99, s5, 1
  s_lshl_b32 s99, s99, 5
  s_add_u32 s98, s98, s99
  s_and_b32 s99, s5, 1
  s_lshl_b32 s99, s99, 3
  s_add_u32 s98, s98, s99
  s_add_u32 s98, s98, 282624
  v_bfe_u32 v15, v0, 1, 1
  v_lshlrev_b32 v15, 4, v15
  v_bfe_u32 v23, v0, 2, 1
  v_lshl_add_u32 v15, v23, 2, v15
  v_add_u32 v15, s98, v15
  v_add_f32 v16, v16, v17
  L_gwait_50:
  s_lshl_b32 s66, s51, 3
  s_add_u32 s66, s66, 4
  v_mov_b32 v96, 0
  v_mov_b32 v97, 0
  v_mov_b32 v98, 0
  v_mov_b32 v99, 0
  v_mov_b32 v100, 0
  v_mov_b32 v101, 0
  v_mov_b32 v102, 0
  v_mov_b32 v103, 0
  s_lshl_b32 s1, s4, 11
  s_add_u32 s1, s1, s50
  s_add_u32 s1, s1, 266240
  s_lshl_b32 s99, s51, 3
  s_add_u32 s99, s99, 3
  v_mov_b32 v22, 163136
  L_tok_51:
  ds_read_b32 v23, v22
  s_waitcnt lgkmcnt(0)
  v_readfirstlane_b32 s98, v23
  s_nop 0
  s_cmp_ge_u32 s98, s99
  s_cbranch_scc1 L_tokok_52
  s_sub_u32 s53, s53, 1
  s_cmp_gt_i32 s53, 0
  s_cbranch_scc1 L_tok_51
  L_tokok_52:
  s_mov_b64 exec, s[92:93]
  L_poll_53:
  buffer_load_dwordx4 v[96:99], v12, s[8:11], s1 offen sc1
  buffer_load_dwordx4 v[100:103], v12, s[8:11], s1 offen offset:16 sc1
  s_waitcnt vmcnt(0)
  v_max_u32 v80, v96, v97
  v_max3_u32 v80, v98, v99, v80
  v_max3_u32 v80, v100, v101, v80
  v_max3_u32 v80, v102, v103, v80
  v_cmp_eq_u32 vcc, -1, v80
  s_nop 0
  s_cbranch_vccnz L_retry_55
  L_pollok_54:
  L_gcomp_49:
  ds_write_b128 v13, v[96:99]
  ds_write_b128 v13, v[100:103] offset:16
  s_mov_b64 exec, -1
  ds_read_b128 v[80:83], v14 offset:0
  ds_read_b128 v[84:87], v14 offset:128
  ds_read_b128 v[88:91], v14 offset:256
  v_mov_b32 v12, 0
  v_mov_b32 v23, 0
  v_dot2c_f32_bf16 v12, s96, v96
  v_dot2c_f32_bf16 v23, v96, v96
  v_dot2c_f32_bf16 v12, s96, v97
  v_dot2c_f32_bf16 v23, v97, v97
  v_dot2c_f32_bf16 v12, s96, v98
  v_dot2c_f32_bf16 v23, v98, v98
  v_dot2c_f32_bf16 v12, s96, v99
  v_dot2c_f32_bf16 v23, v99, v99
  v_dot2c_f32_bf16 v12, s96, v100
  v_dot2c_f32_bf16 v23, v100, v100
  v_dot2c_f32_bf16 v12, s96, v101
  v_dot2c_f32_bf16 v23, v101, v101
  v_dot2c_f32_bf16 v12, s96, v102
  v_dot2c_f32_bf16 v23, v102, v102
  v_dot2c_f32_bf16 v12, s96, v103
  v_dot2c_f32_bf16 v23, v103, v103
  s_waitcnt lgkmcnt(2)
  v_smfmac_f32_16x16x64_bf16 v[92:95], v[80:83], v[24:31], v8
  ds_read_b128 v[80:83], v14 offset:384
  v_add_f32_dpp v12, v12, v12 quad_perm:[2,3,0,1] row_mask:0xf bank_mask:0xf
  v_add_f32_dpp v23, v23, v23 quad_perm:[2,3,0,1] row_mask:0xf bank_mask:0xf
  s_waitcnt lgkmcnt(2)
  v_smfmac_f32_16x16x64_bf16 v[92:95], v[84:87], v[32:39], v8
  ds_read_b128 v[84:87], v14 offset:512
  v_add_f32_dpp v12, v12, v12 row_ror:4 row_mask:0xf bank_mask:0xf
  v_add_f32_dpp v23, v23, v23 row_ror:4 row_mask:0xf bank_mask:0xf
  s_waitcnt lgkmcnt(2)
  v_smfmac_f32_16x16x64_bf16 v[92:95], v[88:91], v[40:47], v8
  ds_read_b128 v[88:91], v14 offset:640
  v_add_f32_dpp v12, v12, v12 row_ror:8 row_mask:0xf bank_mask:0xf
  v_add_f32_dpp v23, v23, v23 row_ror:8 row_mask:0xf bank_mask:0xf
  s_waitcnt lgkmcnt(2)
  v_smfmac_f32_16x16x64_bf16 v[92:95], v[80:83], v[48:55], v8
  ds_read_b128 v[80:83], v14 offset:768
  v_permlane16_swap_b32 v12, v23
  s_waitcnt lgkmcnt(2)
  v_smfmac_f32_16x16x64_bf16 v[92:95], v[84:87], v[56:63], v8
  v_add_f32 v12, v12, v23
  v_mov_b32 v23, v12
  s_waitcnt lgkmcnt(1)
  v_smfmac_f32_16x16x64_bf16 v[92:95], v[88:91], v[64:71], v8
  v_permlane32_swap_b32 v12, v23
  s_waitcnt lgkmcnt(0)
  v_smfmac_f32_16x16x64_bf16 v[92:95], v[80:83], v[72:79], v8
  v_add_f32 v12, v12, v23
  v_mov_b32 v23, v12
  s_nop 1
  v_permlane16_swap_b32 v12, v23
  s_nop 0
  v_mul_f32 v12, 0x3b124925, v12
  v_mul_f32 v23, 0x3b124925, v23
  v_fma_f32 v23, -v12, v12, v23
  v_add_f32 v23, 0x3727c5ac, v23
  v_rsq_f32 v23, v23
  s_nop 0
  v_mul_f32 v12, v12, v23
  v_mov_b32_dpp v96, v23 quad_perm:[0,0,2,2] row_mask:0xf bank_mask:0xf
  v_mov_b32_dpp v97, v23 quad_perm:[1,1,3,3] row_mask:0xf bank_mask:0xf
  v_mov_b32_dpp v98, v12 quad_perm:[0,0,2,2] row_mask:0xf bank_mask:0xf
  v_mov_b32_dpp v99, v12 quad_perm:[1,1,3,3] row_mask:0xf bank_mask:0xf
  v_mul_f32 v98, v98, v16
  v_mul_f32 v99, v99, v16
  v_mov_b32 v12, s66
  v_mov_b32 v22, 163136
  ds_max_u32 v22, v12
  v_add_f32 v100, v92, v93
  v_add_f32 v101, v94, v95
  v_fma_f32 v100, v100, v96, -v98
  v_fma_f32 v101, v101, v97, -v99
  s_nop 0
  v_mov_b32_dpp v102, v100 row_ror:8 row_mask:0xf bank_mask:0xf
  v_mov_b32_dpp v103, v101 row_ror:8 row_mask:0xf bank_mask:0xf
  v_max_f32 v100, 0, v100
  v_max_f32 v101, 0, v101
  v_mul_f32 v100, v100, v102
  v_mul_f32 v101, v101, v103
  s_nop 0
  v_mov_b32_dpp v102, v100 quad_perm:[1,0,3,2] row_mask:0xf bank_mask:0xf
  v_mov_b32_dpp v103, v101 quad_perm:[1,0,3,2] row_mask:0xf bank_mask:0xf
  v_cvt_pk_bf16_f32 v100, v100, v102
  v_cvt_pk_bf16_f32 v101, v101, v103
  s_mov_b64 exec, 0x55
  s_cmp_eq_u32 s52, 0
  s_cbranch_scc1 L_pubslow_56
  buffer_store_dword v100, v15, s[8:11], s50 offen
  L_pubdone_57:
  s_cmp_eq_u32 s52, 0
  s_cbranch_scc1 L_pubslow_58
  buffer_store_dword v101, v15, s[8:11], s50 offen offset:448
  L_pubdone_59:
  s_mov_b64 exec, -1
  s_branch L_next_44
  L_cw_40:
  s_cmp_eq_u32 s3, 1
  s_cbranch_scc1 L_cw_41
  s_cmp_eq_u32 s3, 2
  s_cbranch_scc1 L_cw_42
  s_cmp_ge_u32 s7, 14
  s_cbranch_scc1 L_s2skip_60
  v_lshrrev_b32 v12, 2, v1
  v_lshl_add_u32 v12, v2, 3, v12
  v_lshlrev_b32 v12, 6, v12
  v_and_b32 v23, 3, v0
  v_lshl_add_u32 v12, v23, 3, v12
  v_add_u32 v12, 106496, v12
  ds_read_b64_tr_b16 v[24:25], v12 offset:0
  ds_read_b64_tr_b16 v[26:27], v12 offset:256
  ds_read_b64_tr_b16 v[28:29], v12 offset:2048
  ds_read_b64_tr_b16 v[30:31], v12 offset:2304
  ds_read_b64_tr_b16 v[32:33], v12 offset:4096
  ds_read_b64_tr_b16 v[34:35], v12 offset:4352
  ds_read_b64_tr_b16 v[36:37], v12 offset:6144
  ds_read_b64_tr_b16 v[38:39], v12 offset:6400
  ds_read_b64_tr_b16 v[40:41], v12 offset:32
  ds_read_b64_tr_b16 v[42:43], v12 offset:288
  ds_read_b64_tr_b16 v[44:45], v12 offset:2080
  ds_read_b64_tr_b16 v[46:47], v12 offset:2336
  ds_read_b64_tr_b16 v[48:49], v12 offset:4128
  ds_read_b64_tr_b16 v[50:51], v12 offset:4384
  ds_read_b64_tr_b16 v[52:53], v12 offset:6176
  ds_read_b64_tr_b16 v[54:55], v12 offset:6432
  s_lshl_b32 s98, s6, 13
  s_add_u32 s98, s98, 16384
  v_lshlrev_b32 v13, 9, v1
  v_lshl_add_u32 v13, v2, 4, v13
  v_add_u32 v13, s98, v13
  s_lshl_b32 s98, s6, 7
  s_add_u32 s98, s98, 147456
  v_lshlrev_b32 v14, 3, v1
  v_add_u32 v14, s98, v14
  s_lshl_b32 s98, s7, 12
  s_lshl_b32 s99, s6, 7
  s_add_u32 s98, s98, s99
  s_add_u32 s98, s98, 151552
  v_lshrrev_b32 v15, 3, v1
  v_lshlrev_b32 v15, 6, v15
  v_lshl_add_u32 v15, v2, 4, v15
  v_add_u32 v15, s98, v15
  v_lshrrev_b32 v16, 3, v1
  v_lshl_add_u32 v16, v16, 2, v2
  v_lshlrev_b32 v16, 5, v16
  v_add_u32 v16, 162880, v16
  s_lshl_b32 s99, s51, 3
  s_add_u32 s99, s99, 1
  v_mov_b32 v22, 163136
  L_tok_61:
  ds_read_b32 v23, v22
  s_waitcnt lgkmcnt(0)
  v_readfirstlane_b32 s98, v23
  s_nop 0
  s_cmp_ge_u32 s98, s99
  s_cbranch_scc1 L_tokok_62
  s_sub_u32 s53, s53, 1
  s_cmp_gt_i32 s53, 0
  s_cbranch_scc1 L_tok_61
  L_tokok_62:
  L_poll_63:
  buffer_load_dwordx2 v[88:89], v14, s[8:11], s50 offen sc1
  buffer_load_dwordx4 v[56:59], v13, s[8:11], s50 offen offset:0 sc1
  buffer_load_dwordx4 v[60:63], v13, s[8:11], s50 offen offset:64 sc1
  buffer_load_dwordx4 v[64:67], v13, s[8:11], s50 offen offset:128 sc1
  buffer_load_dwordx4 v[68:71], v13, s[8:11], s50 offen offset:192 sc1
  s_waitcnt vmcnt(0)
  v_max_u32 v90, v88, v89
  v_max3_u32 v90, v56, v57, v90
  v_max3_u32 v90, v58, v59, v90
  v_max3_u32 v90, v60, v61, v90
  v_max3_u32 v90, v62, v63, v90
  v_max3_u32 v90, v64, v65, v90
  v_max3_u32 v90, v66, v67, v90
  v_max3_u32 v90, v68, v69, v90
  v_max3_u32 v90, v70, v71, v90
  v_cmp_eq_u32 vcc, -1, v90
  s_nop 0
  s_cbranch_vccnz L_retry_65
  L_pollok_64:
  s_waitcnt lgkmcnt(0)
  v_mfma_f32_16x16x32_bf16 v[92:95], v[24:27], v[56:59], 0
  v_max_f32_dpp v90, v88, v88 quad_perm:[1,0,3,2] row_mask:0xf bank_mask:0xf
  s_nop 1
  v_max_f32_dpp v90, v90, v90 quad_perm:[2,3,0,1] row_mask:0xf bank_mask:0xf
  v_mfma_f32_16x16x32_bf16 v[96:99], v[40:43], v[56:59], 0
  s_nop 0
  v_max_f32_dpp v90, v90, v90 row_half_mirror row_mask:0xf bank_mask:0xf
  v_sub_f32 v91, v88, v90
  v_mfma_f32_16x16x32_bf16 v[92:95], v[28:31], v[60:63], v[92:95]
  v_exp_f32 v91, v91
  s_nop 0
  v_mul_f32 v102, v91, v89
  v_mfma_f32_16x16x32_bf16 v[96:99], v[44:47], v[60:63], v[96:99]
  s_nop 0
  v_add_f32_dpp v102, v102, v102 quad_perm:[1,0,3,2] row_mask:0xf bank_mask:0xf
  s_nop 1
  v_add_f32_dpp v102, v102, v102 quad_perm:[2,3,0,1] row_mask:0xf bank_mask:0xf
  v_mfma_f32_16x16x32_bf16 v[92:95], v[32:35], v[64:67], v[92:95]
  s_nop 0
  v_add_f32_dpp v102, v102, v102 row_half_mirror row_mask:0xf bank_mask:0xf
  v_rcp_f32 v102, v102
  v_mfma_f32_16x16x32_bf16 v[96:99], v[48:51], v[64:67], v[96:99]
  v_mul_f32 v91, v91, v102
  v_mfma_f32_16x16x32_bf16 v[92:95], v[36:39], v[68:71], v[92:95]
  v_mfma_f32_16x16x32_bf16 v[96:99], v[52:55], v[68:71], v[96:99]
  s_nop 6
  v_mul_f32 v92, v92, v91
  v_mul_f32 v93, v93, v91
  v_mul_f32 v94, v94, v91
  v_mul_f32 v95, v95, v91
  v_mul_f32 v96, v96, v91
  v_mul_f32 v97, v97, v91
  v_mul_f32 v98, v98, v91
  v_mul_f32 v99, v99, v91
  v_add_f32_dpp v92, v92, v92 quad_perm:[1,0,3,2] row_mask:0xf bank_mask:0xf
  v_add_f32_dpp v93, v93, v93 quad_perm:[1,0,3,2] row_mask:0xf bank_mask:0xf
  v_add_f32_dpp v94, v94, v94 quad_perm:[1,0,3,2] row_mask:0xf bank_mask:0xf
  v_add_f32_dpp v95, v95, v95 quad_perm:[1,0,3,2] row_mask:0xf bank_mask:0xf
  v_add_f32_dpp v96, v96, v96 quad_perm:[1,0,3,2] row_mask:0xf bank_mask:0xf
  v_add_f32_dpp v97, v97, v97 quad_perm:[1,0,3,2] row_mask:0xf bank_mask:0xf
  v_add_f32_dpp v98, v98, v98 quad_perm:[1,0,3,2] row_mask:0xf bank_mask:0xf
  v_add_f32_dpp v99, v99, v99 quad_perm:[1,0,3,2] row_mask:0xf bank_mask:0xf
  v_add_f32_dpp v92, v92, v92 quad_perm:[2,3,0,1] row_mask:0xf bank_mask:0xf
  v_add_f32_dpp v93, v93, v93 quad_perm:[2,3,0,1] row_mask:0xf bank_mask:0xf
  v_add_f32_dpp v94, v94, v94 quad_perm:[2,3,0,1] row_mask:0xf bank_mask:0xf
  v_add_f32_dpp v95, v95, v95 quad_perm:[2,3,0,1] row_mask:0xf bank_mask:0xf
  v_add_f32_dpp v96, v96, v96 quad_perm:[2,3,0,1] row_mask:0xf bank_mask:0xf
  v_add_f32_dpp v97, v97, v97 quad_perm:[2,3,0,1] row_mask:0xf bank_mask:0xf
  v_add_f32_dpp v98, v98, v98 quad_perm:[2,3,0,1] row_mask:0xf bank_mask:0xf
  v_add_f32_dpp v99, v99, v99 quad_perm:[2,3,0,1] row_mask:0xf bank_mask:0xf
  v_add_f32_dpp v92, v92, v92 row_half_mirror row_mask:0xf bank_mask:0xf
  v_add_f32_dpp v93, v93, v93 row_half_mirror row_mask:0xf bank_mask:0xf
  v_add_f32_dpp v94, v94, v94 row_half_mirror row_mask:0xf bank_mask:0xf
  v_add_f32_dpp v95, v95, v95 row_half_mirror row_mask:0xf bank_mask:0xf
  v_add_f32_dpp v96, v96, v96 row_half_mirror row_mask:0xf bank_mask:0xf
  v_add_f32_dpp v97, v97, v97 row_half_mirror row_mask:0xf bank_mask:0xf
  v_add_f32_dpp v98, v98, v98 row_half_mirror row_mask:0xf bank_mask:0xf
  v_add_f32_dpp v99, v99, v99 row_half_mirror row_mask:0xf bank_mask:0xf
  s_mov_b64 exec, s[88:89]
  L_mb_66:
  ds_read_b128 v[24:27], v16
  ds_read_b128 v[28:31], v16 offset:16
  s_waitcnt lgkmcnt(0)
  v_max_u32 v32, v24, v25
  v_max3_u32 v32, v26, v27, v32
  v_max3_u32 v32, v28, v29, v32
  v_max3_u32 v32, v30, v31, v32
  v_cmp_eq_u32 vcc, -1, v32
  s_nop 0
  s_cbranch_vccnz L_mbr_68
  L_mbok_67:
  v_add_f32 v92, v92, v24
  v_add_f32 v93, v93, v25
  v_add_f32 v94, v94, v26
  v_add_f32 v95, v95, v27
  v_add_f32 v96, v96, v28
  v_add_f32 v97, v97, v29
  v_add_f32 v98, v98, v30
  v_add_f32 v99, v99, v31
  buffer_store_dwordx4 v[92:95], v15, s[8:11], s50 offen sc1
  buffer_store_dwordx4 v[96:99], v15, s[8:11], s50 offen offset:2048 sc1
  v_mov_b32 v24, -1
  v_mov_b32 v25, -1
  v_mov_b32 v26, -1
  v_mov_b32 v27, -1
  ds_write_b128 v16, v[24:27]
  ds_write_b128 v16, v[24:27] offset:16
  s_mov_b64 exec, -1
  L_s2skip_60:
  s_cmp_ge_u32 s5, 28
  s_cbranch_scc0 L_t2_69
  s_lshl_b32 s98, s51, 3
  s_add_u32 s98, s98, 2
  v_mov_b32 v23, s98
  v_mov_b32 v22, 163136
  ds_max_u32 v22, v23
  L_t2_69:
  s_cmp_ge_u32 s5, 28
  s_cbranch_scc1 L_next_44
  v_lshrrev_b32 v12, 2, v1
  v_lshl_add_u32 v12, v2, 3, v12
  v_lshlrev_b32 v12, 5, v12
  v_and_b32 v23, 3, v0
  v_lshl_add_u32 v12, v23, 3, v12
  v_add_u32 v12, 151552, v12
  ds_read_b64_tr_b16 v[24:25], v12 offset:0
  ds_read_b64_tr_b16 v[26:27], v12 offset:128
  ds_read_b64_tr_b16 v[28:29], v12 offset:1024
  ds_read_b64_tr_b16 v[30:31], v12 offset:1152
  ds_read_b64_tr_b16 v[32:33], v12 offset:2048
  ds_read_b64_tr_b16 v[34:35], v12 offset:2176
  ds_read_b64_tr_b16 v[36:37], v12 offset:3072
  ds_read_b64_tr_b16 v[38:39], v12 offset:3200
  ds_read_b64_tr_b16 v[40:41], v12 offset:4096
  ds_read_b64_tr_b16 v[42:43], v12 offset:4224
  ds_read_b64_tr_b16 v[44:45], v12 offset:5120
  ds_read_b64_tr_b16 v[46:47], v12 offset:5248
  ds_read_b64_tr_b16 v[48:49], v12 offset:6144
  ds_read_b64_tr_b16 v[50:51], v12 offset:6272
  v_mov_b32 v52, 0
  v_mov_b32 v84, 0
  v_mov_b32 v53, 0
  v_mov_b32 v85, 0
  v_mov_b32 v54, 0
  v_mov_b32 v86, 0
  v_mov_b32 v55, 0
  v_mov_b32 v87, 0
  s_lshl_b32 s98, s4, 10
  s_add_u32 s98, s98, 282624
  v_bfe_u32 v13, v0, 1, 1
  v_mul_u32_u24 v13, 448, v13
  v_lshl_add_u32 v13, v2, 5, v13
  v_and_b32 v23, 1, v0
  v_lshl_add_u32 v13, v23, 4, v13
  v_add_u32 v13, s98, v13
  v_mov_b32 v14, 2130706432
  v_cmp_gt_u32 vcc, 32, v0
  s_nop 1
  v_cndmask_b32 v14, v14, v13, vcc
  s_lshl_b32 s98, s5, 10
  s_lshl_b32 s99, s4, 7
  s_add_u32 s98, s98, s99
  s_add_u32 s98, s98, 290816
  v_lshlrev_b32 v15, 2, v0
  v_add_u32 v15, s98, v15
  s_mov_b32 s64, 0xFFFF0000
  s_mov_b32 s65, 0
  s_lshl_b32 s98, s51, 3
  s_add_u32 s98, s98, 2
  v_mov_b32 v23, s98
  v_mov_b32 v22, 163136
  ds_max_u32 v22, v23
  L_dwait_71:
  s_lshl_b32 s99, s51, 3
  s_add_u32 s99, s99, 4
  v_mov_b32 v22, 163136
  L_tok_72:
  ds_read_b32 v23, v22
  s_waitcnt lgkmcnt(0)
  v_readfirstlane_b32 s98, v23
  s_nop 0
  s_cmp_ge_u32 s98, s99
  s_cbranch_scc1 L_tokok_73
  s_sub_u32 s53, s53, 1
  s_cmp_gt_i32 s53, 0
  s_cbranch_scc1 L_tok_72
  L_tokok_73:
  L_poll_74:
  buffer_load_dwordx4 v[56:59], v13, s[8:11], s50 offen offset:0 sc1
  buffer_load_dwordx4 v[60:63], v13, s[8:11], s50 offen offset:128 sc1
  buffer_load_dwordx4 v[64:67], v13, s[8:11], s50 offen offset:256 sc1
  buffer_load_dwordx4 v[68:71], v14, s[8:11], s50 offen offset:384 sc1
  s_waitcnt vmcnt(0)
  v_max_u32 v80, v56, v57
  v_max3_u32 v80, v58, v59, v80
  v_max3_u32 v80, v60, v61, v80
  v_max3_u32 v80, v62, v63, v80
  v_max3_u32 v80, v64, v65, v80
  v_max3_u32 v80, v66, v67, v80
  v_max3_u32 v80, v68, v69, v80
  v_max3_u32 v80, v70, v71, v80
  v_cmp_eq_u32 vcc, -1, v80
  s_nop 0
  s_cbranch_vccnz L_retry_76
  L_pollok_75:
  s_waitcnt lgkmcnt(0)
  L_dcomp_70:
  v_smfmac_f32_16x16x64_bf16 v[84:87], v[56:59], v[24:31], v8
  v_smfmac_f32_16x16x64_bf16 v[84:87], v[60:63], v[32:39], v8
  v_smfmac_f32_16x16x64_bf16 v[84:87], v[64:67], v[40:47], v8
  v_smfmac_f32_16x16x64_bf16 v[84:87], v[68:71], v[48:55], v8
  s_nop 7
  v_add_f32 v80, v84, v85
  v_add_f32 v81, v86, v87
  v_cndmask_b32 v80, v80, v81, s[64:65]
  s_mov_b32 exec_hi, 0
  buffer_store_dword v80, v15, s[8:11], s50 offen sc1
  s_mov_b64 exec, -1
  s_lshl_b32 s98, s51, 3
  s_add_u32 s98, s98, 5
  v_mov_b32 v23, s98
  v_mov_b32 v22, 163136
  ds_max_u32 v22, v23
  s_branch L_next_44
  L_cw_41:
  s_cmp_ge_u32 s7, 14
  s_cbranch_scc1 L_s2skip_77
  v_lshrrev_b32 v12, 2, v1
  v_lshl_add_u32 v12, v2, 3, v12
  v_lshlrev_b32 v12, 6, v12
  v_and_b32 v23, 3, v0
  v_lshl_add_u32 v12, v23, 3, v12
  v_add_u32 v12, 114688, v12
  ds_read_b64_tr_b16 v[24:25], v12 offset:0
  ds_read_b64_tr_b16 v[26:27], v12 offset:256
  ds_read_b64_tr_b16 v[28:29], v12 offset:2048
  ds_read_b64_tr_b16 v[30:31], v12 offset:2304
  ds_read_b64_tr_b16 v[32:33], v12 offset:4096
  ds_read_b64_tr_b16 v[34:35], v12 offset:4352
  ds_read_b64_tr_b16 v[36:37], v12 offset:6144
  ds_read_b64_tr_b16 v[38:39], v12 offset:6400
  ds_read_b64_tr_b16 v[40:41], v12 offset:32
  ds_read_b64_tr_b16 v[42:43], v12 offset:288
  ds_read_b64_tr_b16 v[44:45], v12 offset:2080
  ds_read_b64_tr_b16 v[46:47], v12 offset:2336
  ds_read_b64_tr_b16 v[48:49], v12 offset:4128
  ds_read_b64_tr_b16 v[50:51], v12 offset:4384
  ds_read_b64_tr_b16 v[52:53], v12 offset:6176
  ds_read_b64_tr_b16 v[54:55], v12 offset:6432
  s_lshl_b32 s98, s6, 13
  s_add_u32 s98, s98, 16640
  v_lshlrev_b32 v13, 9, v1
  v_lshl_add_u32 v13, v2, 4, v13
  v_add_u32 v13, s98, v13
  s_lshl_b32 s98, s6, 7
  s_add_u32 s98, s98, 147456
  v_lshlrev_b32 v14, 3, v1
  v_add_u32 v14, s98, v14
  v_lshrrev_b32 v16, 3, v1
  v_lshl_add_u32 v16, v16, 2, v2
  v_lshlrev_b32 v16, 5, v16
  v_add_u32 v16, 162880, v16
  s_lshl_b32 s99, s51, 3
  s_add_u32 s99, s99, 1
  v_mov_b32 v22, 163136
  L_tok_78:
  ds_read_b32 v23, v22
  s_waitcnt lgkmcnt(0)
  v_readfirstlane_b32 s98, v23
  s_nop 0
  s_cmp_ge_u32 s98, s99
  s_cbranch_scc1 L_tokok_79
  s_sub_u32 s53, s53, 1
  s_cmp_gt_i32 s53, 0
  s_cbranch_scc1 L_tok_78
  L_tokok_79:
  L_poll_80:
  buffer_load_dwordx2 v[88:89], v14, s[8:11], s50 offen sc1
  buffer_load_dwordx4 v[56:59], v13, s[8:11], s50 offen offset:0 sc1
  buffer_load_dwordx4 v[60:63], v13, s[8:11], s50 offen offset:64 sc1
  buffer_load_dwordx4 v[64:67], v13, s[8:11], s50 offen offset:128 sc1
  buffer_load_dwordx4 v[68:71], v13, s[8:11], s50 offen offset:192 sc1
  s_waitcnt vmcnt(0)
  v_max_u32 v90, v88, v89
  v_max3_u32 v90, v56, v57, v90
  v_max3_u32 v90, v58, v59, v90
  v_max3_u32 v90, v60, v61, v90
  v_max3_u32 v90, v62, v63, v90
  v_max3_u32 v90, v64, v65, v90
  v_max3_u32 v90, v66, v67, v90
  v_max3_u32 v90, v68, v69, v90
  v_max3_u32 v90, v70, v71, v90
  v_cmp_eq_u32 vcc, -1, v90
  s_nop 0
  s_cbranch_vccnz L_retry_82
  L_pollok_81:
  s_waitcnt lgkmcnt(0)
  v_mfma_f32_16x16x32_bf16 v[92:95], v[24:27], v[56:59], 0
  v_max_f32_dpp v90, v88, v88 quad_perm:[1,0,3,2] row_mask:0xf bank_mask:0xf
  s_nop 1
  v_max_f32_dpp v90, v90, v90 quad_perm:[2,3,0,1] row_mask:0xf bank_mask:0xf
  v_mfma_f32_16x16x32_bf16 v[96:99], v[40:43], v[56:59], 0
  s_nop 0
  v_max_f32_dpp v90, v90, v90 row_half_mirror row_mask:0xf bank_mask:0xf
  v_sub_f32 v91, v88, v90
  v_mfma_f32_16x16x32_bf16 v[92:95], v[28:31], v[60:63], v[92:95]
  v_exp_f32 v91, v91
  s_nop 0
  v_mul_f32 v102, v91, v89
  v_mfma_f32_16x16x32_bf16 v[96:99], v[44:47], v[60:63], v[96:99]
  s_nop 0
  v_add_f32_dpp v102, v102, v102 quad_perm:[1,0,3,2] row_mask:0xf bank_mask:0xf
  s_nop 1
  v_add_f32_dpp v102, v102, v102 quad_perm:[2,3,0,1] row_mask:0xf bank_mask:0xf
  v_mfma_f32_16x16x32_bf16 v[92:95], v[32:35], v[64:67], v[92:95]
  s_nop 0
  v_add_f32_dpp v102, v102, v102 row_half_mirror row_mask:0xf bank_mask:0xf
  v_rcp_f32 v102, v102
  v_mfma_f32_16x16x32_bf16 v[96:99], v[48:51], v[64:67], v[96:99]
  v_mul_f32 v91, v91, v102
  v_mfma_f32_16x16x32_bf16 v[92:95], v[36:39], v[68:71], v[92:95]
  v_mfma_f32_16x16x32_bf16 v[96:99], v[52:55], v[68:71], v[96:99]
  s_nop 6
  v_mul_f32 v92, v92, v91
  v_mul_f32 v93, v93, v91
  v_mul_f32 v94, v94, v91
  v_mul_f32 v95, v95, v91
  v_mul_f32 v96, v96, v91
  v_mul_f32 v97, v97, v91
  v_mul_f32 v98, v98, v91
  v_mul_f32 v99, v99, v91
  v_add_f32_dpp v92, v92, v92 quad_perm:[1,0,3,2] row_mask:0xf bank_mask:0xf
  v_add_f32_dpp v93, v93, v93 quad_perm:[1,0,3,2] row_mask:0xf bank_mask:0xf
  v_add_f32_dpp v94, v94, v94 quad_perm:[1,0,3,2] row_mask:0xf bank_mask:0xf
  v_add_f32_dpp v95, v95, v95 quad_perm:[1,0,3,2] row_mask:0xf bank_mask:0xf
  v_add_f32_dpp v96, v96, v96 quad_perm:[1,0,3,2] row_mask:0xf bank_mask:0xf
  v_add_f32_dpp v97, v97, v97 quad_perm:[1,0,3,2] row_mask:0xf bank_mask:0xf
  v_add_f32_dpp v98, v98, v98 quad_perm:[1,0,3,2] row_mask:0xf bank_mask:0xf
  v_add_f32_dpp v99, v99, v99 quad_perm:[1,0,3,2] row_mask:0xf bank_mask:0xf
  v_add_f32_dpp v92, v92, v92 quad_perm:[2,3,0,1] row_mask:0xf bank_mask:0xf
  v_add_f32_dpp v93, v93, v93 quad_perm:[2,3,0,1] row_mask:0xf bank_mask:0xf
  v_add_f32_dpp v94, v94, v94 quad_perm:[2,3,0,1] row_mask:0xf bank_mask:0xf
  v_add_f32_dpp v95, v95, v95 quad_perm:[2,3,0,1] row_mask:0xf bank_mask:0xf
  v_add_f32_dpp v96, v96, v96 quad_perm:[2,3,0,1] row_mask:0xf bank_mask:0xf
  v_add_f32_dpp v97, v97, v97 quad_perm:[2,3,0,1] row_mask:0xf bank_mask:0xf
  v_add_f32_dpp v98, v98, v98 quad_perm:[2,3,0,1] row_mask:0xf bank_mask:0xf
  v_add_f32_dpp v99, v99, v99 quad_perm:[2,3,0,1] row_mask:0xf bank_mask:0xf
  v_add_f32_dpp v92, v92, v92 row_half_mirror row_mask:0xf bank_mask:0xf
  v_add_f32_dpp v93, v93, v93 row_half_mirror row_mask:0xf bank_mask:0xf
  v_add_f32_dpp v94, v94, v94 row_half_mirror row_mask:0xf bank_mask:0xf
  v_add_f32_dpp v95, v95, v95 row_half_mirror row_mask:0xf bank_mask:0xf
  v_add_f32_dpp v96, v96, v96 row_half_mirror row_mask:0xf bank_mask:0xf
  v_add_f32_dpp v97, v97, v97 row_half_mirror row_mask:0xf bank_mask:0xf
  v_add_f32_dpp v98, v98, v98 row_half_mirror row_mask:0xf bank_mask:0xf
  v_add_f32_dpp v99, v99, v99 row_half_mirror row_mask:0xf bank_mask:0xf
  s_mov_b64 exec, s[88:89]
  ds_write_b128 v16, v[92:95]
  ds_write_b128 v16, v[96:99] offset:16
  s_mov_b64 exec, -1
  L_s2skip_77:
  s_lshl_b32 s98, s4, 11
  s_add_u32 s98, s98, 655360
  s_add_u32 s40, s8, s98
  s_addc_u32 s41, s9, 0
  s_waitcnt vmcnt(0)
  s_branch L_next_44
  L_cw_42:
  s_cmp_ge_u32 s5, 28
  s_cbranch_scc1 L_next_44
  L_rwait_84:
  s_lshl_b32 s99, s51, 3
  s_add_u32 s99, s99, 2
  v_mov_b32 v22, 163136
  L_tok_85:
  ds_read_b32 v23, v22
  s_waitcnt lgkmcnt(0)
  v_readfirstlane_b32 s98, v23
  s_nop 0
  s_cmp_ge_u32 s98, s99
  s_cbranch_scc1 L_tokok_86
  s_sub_u32 s53, s53, 1
  s_cmp_gt_i32 s53, 0
  s_cbranch_scc1 L_tok_85
  L_tokok_86:
  s_lshl_b32 s98, s5, 11
  s_add_u32 s98, s98, 151552
  v_lshlrev_b32 v12, 4, v0
  v_add_u32 v12, s98, v12
  s_lshl_b32 s98, s5, 5
  s_lshl_b32 s99, s4, 11
  s_add_u32 s98, s98, s99
  s_add_u32 s98, s98, 266240
  v_bfe_u32 v13, v0, 2, 1
  v_mul_u32_u24 v13, 896, v13
  v_and_b32 v23, 3, v0
  v_lshl_add_u32 v13, v23, 2, v13
  v_lshrrev_b32 v23, 5, v0
  v_lshl_add_u32 v13, v23, 4, v13
  v_add_u32 v13, s98, v13
  L_poll_87:
  buffer_load_dwordx4 v[24:27], v12, s[8:11], s50 offen offset:0 sc1
  buffer_load_dwordx4 v[28:31], v12, s[8:11], s50 offen offset:1024 sc1
  s_waitcnt vmcnt(0)
  v_max_u32 v64, v24, v25
  v_max3_u32 v64, v26, v27, v64
  v_max3_u32 v64, v28, v29, v64
  v_max3_u32 v64, v30, v31, v64
  v_cmp_eq_u32 vcc, -1, v64
  s_nop 0
  s_cbranch_vccnz L_retry_89
  L_pollok_88:
  v_add_f32 v56, v24, v28
  v_add_f32 v57, v25, v29
  v_add_f32 v58, v26, v30
  v_add_f32 v59, v27, v31
  s_lshl_b32 s98, s51, 3
  s_add_u32 s98, s98, 3
  v_mov_b32 v23, s98
  v_mov_b32 v22, 163136
  ds_max_u32 v22, v23
  L_rcomp_83:
  v_permlane16_swap_b32 v56, v57
  v_permlane16_swap_b32 v58, v59
  v_add_f32 v56, v56, v57
  v_add_f32 v58, v58, v59
  s_nop 1
  v_permlane32_swap_b32 v56, v58
  s_nop 0
  v_add_f32 v56, v56, v58
  s_nop 1
  v_add_f32_dpp v56, v56, v56 row_ror:8 row_mask:0xf bank_mask:0xf
  v_add_f32 v11, v11, v56
  v_mov_b32 v60, v11
  v_mov_b32 v61, v11
  s_nop 1
  v_permlane16_swap_b32 v60, v61
  s_nop 0
  v_cvt_pk_bf16_f32 v60, v60, v61
  s_mov_b64 exec, s[94:95]
  s_cmp_eq_u32 s52, 0
  s_cbranch_scc1 L_pubslow_90
  buffer_store_dword v60, v13, s[8:11], s50 offen
  L_pubdone_91:
  s_mov_b64 exec, -1
  s_cmp_eq_u32 s51, 0
  s_cselect_b32 s98, 0, s4
  s_cmp_eq_u32 s98, 0
  s_cbranch_scc0 L_next_44
  L_rwait_93:
  s_lshl_b32 s99, s51, 3
  s_add_u32 s99, s99, 5
  v_mov_b32 v22, 163136
  L_tok_94:
  ds_read_b32 v23, v22
  s_waitcnt lgkmcnt(0)
  v_readfirstlane_b32 s98, v23
  s_nop 0
  s_cmp_ge_u32 s98, s99
  s_cbranch_scc1 L_tokok_95
  s_sub_u32 s53, s53, 1
  s_cmp_gt_i32 s53, 0
  s_cbranch_scc1 L_tok_94
  L_tokok_95:
  s_lshl_b32 s98, s5, 10
  s_add_u32 s98, s98, 290816
  v_lshlrev_b32 v12, 4, v0
  v_add_u32 v12, s98, v12
  s_lshl_b32 s98, s5, 5
  v_bfe_u32 v13, v0, 2, 1
  v_mul_u32_u24 v13, 896, v13
  v_and_b32 v23, 3, v0
  v_lshl_add_u32 v13, v23, 3, v13
  v_lshrrev_b32 v23, 5, v0
  v_lshl_add_u32 v13, v23, 2, v13
  v_add_u32 v13, s98, v13
  s_lshl_b32 s98, s5, 5
  v_bfe_u32 v14, v0, 2, 1
  v_mul_u32_u24 v14, 896, v14
  v_and_b32 v23, 3, v0
  v_lshl_add_u32 v14, v23, 2, v14
  v_lshrrev_b32 v23, 5, v0
  v_lshl_add_u32 v14, v23, 4, v14
  v_add_u32 v14, s98, v14
  L_poll_96:
  buffer_load_dwordx4 v[56:59], v12, s[8:11], s50 offen sc1
  s_waitcnt vmcnt(0)
  v_max_u32 v64, v56, v57
  v_max3_u32 v64, v58, v59, v64
  v_cmp_eq_u32 vcc, -1, v64
  s_nop 0
  s_cbranch_vccnz L_retry_98
  L_pollok_97:
  s_lshl_b32 s98, s51, 3
  s_add_u32 s98, s98, 6
  v_mov_b32 v23, s98
  v_mov_b32 v22, 163136
  ds_max_u32 v22, v23
  L_rcomp_92:
  v_permlane16_swap_b32 v56, v57
  v_permlane16_swap_b32 v58, v59
  v_add_f32 v56, v56, v57
  v_add_f32 v58, v58, v59
  s_nop 1
  v_permlane32_swap_b32 v56, v58
  s_nop 0
  v_add_f32 v56, v56, v58
  s_nop 1
  v_add_f32_dpp v56, v56, v56 row_ror:8 row_mask:0xf bank_mask:0xf
  v_add_f32 v11, v11, v56
  v_mov_b32 v60, v11
  v_mov_b32 v61, v11
  s_nop 1
  v_permlane16_swap_b32 v60, v61
  s_nop 0
  v_cvt_pk_bf16_f32 v60, v60, v61
  s_mov_b64 exec, s[94:95]
  s_cmp_eq_u32 s51, 0
  s_cbranch_scc0 L_s6fin_99
  s_lshl_b32 s98, s4, 11
  s_add_u32 s98, s98, 655360
  s_cmp_eq_u32 s52, 0
  s_cbranch_scc1 L_pubslow_101
  buffer_store_dword v60, v14, s[8:11], s98 offen
  L_pubdone_102:
  s_branch L_s6done_100
  L_s6fin_99:
  buffer_store_dword v60, v13, s[44:47], 0 offen
  L_s6done_100:
  s_mov_b64 exec, -1
  L_next_44:
  s_cmp_eq_u32 s51, 0
  s_cbranch_scc0 L_fin
  s_mov_b32 s51, 1
  s_mov_b32 s50, 327680
  s_branch L_top
  L_fin:
  L_end:
  s_endpgm
  L_qdm_1:
  v_mov_b32 v23, 2130706432
  buffer_load_dword v246, v23, s[20:23], 0 offen
  s_branch L_qdn_2
  L_retry_16:
  s_sub_u32 s53, s53, 1
  s_cmp_gt_i32 s53, 0
  s_cbranch_scc1 L_poll_14
  s_branch L_pollok_15
  L_pubslow_18:
  buffer_store_dword v100, v15, s[8:11], s98 offen sc1
  s_branch L_pubdone_19
  L_pubslow_20:
  buffer_store_dword v101, v15, s[8:11], s98 offen offset:512 sc1
  s_branch L_pubdone_21
  L_tdm_26:
  v_mov_b32 v23, 2130706432
  buffer_load_dword v246, v23, s[8:11], 0 offen
  s_branch L_tdn_27
  L_tdm_28:
  v_mov_b32 v23, 2130706432
  buffer_load_dword v246, v23, s[8:11], 0 offen
  s_branch L_tdn_29
  L_tdm_30:
  v_mov_b32 v23, 2130706432
  buffer_load_dword v246, v23, s[8:11], 0 offen
  s_branch L_tdn_31
  L_retry_38:
  s_sub_u32 s53, s53, 1
  s_cmp_gt_i32 s53, 0
  s_cbranch_scc1 L_poll_36
  s_branch L_pollok_37
  L_pubslow_45:
  buffer_store_dwordx2 v[28:29], v18, s[8:11], s50 offen sc1
  s_branch L_pubdone_46
  L_pubslow_47:
  buffer_store_dwordx2 v[48:49], v19, s[8:11], s50 offen sc1
  s_branch L_pubdone_48
  L_retry_55:
  s_sub_u32 s53, s53, 1
  s_cmp_gt_i32 s53, 0
  s_cbranch_scc1 L_poll_53
  s_branch L_pollok_54
  L_pubslow_56:
  buffer_store_dword v100, v15, s[8:11], s50 offen sc1
  s_branch L_pubdone_57
  L_pubslow_58:
  buffer_store_dword v101, v15, s[8:11], s50 offen offset:448 sc1
  s_branch L_pubdone_59
  L_retry_65:
  s_sub_u32 s53, s53, 1
  s_cmp_gt_i32 s53, 0
  s_cbranch_scc1 L_poll_63
  s_branch L_pollok_64
  L_mbr_68:
  s_sub_u32 s53, s53, 1
  s_cmp_gt_i32 s53, 0
  s_cbranch_scc1 L_mb_66
  s_branch L_mbok_67
  L_retry_76:
  s_sub_u32 s53, s53, 1
  s_cmp_gt_i32 s53, 0
  s_cbranch_scc1 L_poll_74
  s_branch L_pollok_75
  L_retry_82:
  s_sub_u32 s53, s53, 1
  s_cmp_gt_i32 s53, 0
  s_cbranch_scc1 L_poll_80
  s_branch L_pollok_81
  L_retry_89:
  s_sub_u32 s53, s53, 1
  s_cmp_gt_i32 s53, 0
  s_cbranch_scc1 L_poll_87
  s_branch L_pollok_88
  L_pubslow_90:
  buffer_store_dword v60, v13, s[8:11], s50 offen sc1
  s_branch L_pubdone_91
  L_retry_98:
  s_sub_u32 s53, s53, 1
  s_cmp_gt_i32 s53, 0
  s_cbranch_scc1 L_poll_96
  s_branch L_pollok_97
  L_pubslow_101:
  buffer_store_dword v60, v14, s[8:11], s98 offen sc1
  s_branch L_pubdone_102
.fill (20544 - (. - interleave_layers__mha_block_cached__glu_gated_reglu__decode_kernel)) / 4, 4, 0xBF810000
.section .rodata,"a"
.p2align 6
.amdhsa_kernel interleave_layers__mha_block_cached__glu_gated_reglu__decode_kernel
  .amdhsa_next_free_vgpr 512
  .amdhsa_next_free_sgpr 102
  .amdhsa_accum_offset 256
  .amdhsa_group_segment_fixed_size 0
  .amdhsa_kernarg_size 96
  .amdhsa_user_sgpr_count 2
  .amdhsa_user_sgpr_kernarg_segment_ptr 1
  .amdhsa_system_sgpr_workgroup_id_x 1
.end_amdhsa_kernel
.text
```
